```python
import torch

def _softmax(x, axis=-1):
    return torch.softmax(x, dim=axis)

def _gelu(x):
    return torch.nn.functional.gelu(x, approximate='tanh')

def _silu(x):
    return torch.nn.functional.silu(x)

def _sigmoid(x):
    return torch.sigmoid(x)

def _layernorm(x, axis=-1, eps=1e-05):
    m = x.mean(dim=axis, keepdim=True)
    v = x.var(dim=axis, keepdim=True, unbiased=False)
    return (x - m) / torch.sqrt(v + eps)

def _scatter_add(tgt, idx, src, axis=0):
    return tgt.clone().index_add_(axis, idx, src)

def _segment_sum(src, seg, n):
    out = torch.zeros((n,) + src.shape[1:], dtype=src.dtype)
    return out.index_add_(0, seg, src)

def _pad(x, pw):
    flat = tuple((v for pair in reversed(pw) for v in pair))
    return torch.nn.functional.pad(x, flat)
kernel_name = 'standalone__autoregressive_conv_wavenet__speech'

def setup_inputs():

    _w = lambda a: (lambda t: t.to(torch.bfloat16) if t.is_floating_point() else t)(torch.as_tensor(a))
    B, T, D, K = (2, 16000, 256, 5)
    return {'x': _w((lambda *s: torch.randn(*s, dtype=torch.bfloat16) * 0.1)(B, T, D)), 'w': _w((lambda *s: torch.randn(*s, dtype=torch.bfloat16) * 0.1)(K, D, 2 * D)), 'w_o': _w((lambda *s: torch.randn(*s, dtype=torch.bfloat16) * 0.05)(D, D))}

def reference(x, w, w_o):
    B, T, D = x.shape
    K = w.shape[0]
    dil = 2
    pad = (K - 1) * dil
    xp = _pad(x, ((0, 0), (pad, 0), (0, 0)))
    h = torch.einsum('btc,cd->btd', xp[:, pad:pad + T, :], w[0])
    for i in range(1, K):
        off = pad - i * dil
        h = h + torch.einsum('btc,cd->btd', xp[:, off:off + T, :], w[i])
    f = h[..., :D].clone()
    g = h[..., D:].clone()
    z = torch.tanh(f) * _sigmoid(g)
    return z @ w_o
```

```asm
; @launch grid=(250,1,1) block=(512,1,1) lds=162176
.amdgcn_target "amdgcn-amd-amdhsa--gfx950"
.text
.globl standalone__autoregressive_conv_wavenet__speech_kernel
.p2align 8
.type standalone__autoregressive_conv_wavenet__speech_kernel,@function
standalone__autoregressive_conv_wavenet__speech_kernel:
    s_cmp_ge_u32 s2, 250
    s_cbranch_scc1 L_end
    s_load_dwordx4 s[4:7], s[0:1], 0
    s_load_dwordx4 s[8:11], s[0:1], 16
    v_and_b32 v0, 0x3ff, v0
    v_lshrrev_b32 v1, 6, v0
    s_getpc_b64 s[98:99]
L_pc:
    v_and_b32 v2, 1, v0
    v_lshlrev_b32 v2, 7, v2
    v_lshl_add_u32 v2, v1, 8, v2
    s_lshr_b32 s36, s2, 3
    s_lshl_b32 s36, s36, 10
    s_add_u32 s36, s36, 2048
    v_lshl_add_u32 v3, v1, 7, s36
    v_and_b32 v4, 32, v0
    v_cmp_eq_u32 vcc, 0, v4
    v_cndmask_b32 v2, v3, v2, vcc
    v_min_u32 v2, L_end-L_pc, v2
    global_load_dword v240, v2, s[98:99]
    v_and_b32 v244, 63, v0
    v_readfirstlane_b32 s32, v1
    v_lshrrev_b32 v5, 3, v244
    v_lshlrev_b32 v5, 9, v5
    v_and_b32 v6, 7, v244
    v_lshl_add_u32 v234, v6, 4, v5
    s_lshl_b32 s40, s2, 16
    s_cmp_eq_u32 s2, 0
    s_cselect_b32 s39, 1, 0
    s_cmp_eq_u32 s2, 125
    s_cselect_b32 s39, 1, s39
    s_and_b32 s38, s32, 3
    s_cmp_eq_u32 s38, 0
    s_cselect_b32 s39, s39, 0
    s_mul_i32 s48, s38, 1056
    s_lshl_b32 s49, s38, 12
    s_add_u32 s49, s49, s40
    s_sub_u32 s49, s49, 4096
    s_lshr_b32 s57, s32, 2
    v_lshrrev_b32 v1, 5, v244
    v_bfe_u32 v2, v244, 3, 2
    v_lshlrev_b32 v5, 13, v1
    v_lshl_add_u32 v5, v2, 10, v5
    v_lshrrev_b32 v1, 4, v244
    v_lshlrev_b32 v6, 1, v1
    v_and_b32 v3, 7, v244
    v_xor_b32 v6, v6, v3
    v_lshl_add_u32 v5, v6, 4, v5
    s_lshr_b32 s36, s32, 1
    s_lshl_b32 s36, s36, 7
    s_and_b32 s37, s32, 1
    s_lshl_b32 s37, s37, 9
    s_add_u32 s36, s36, s37
    v_add_u32 v224, s36, v5
    v_add_u32 v225, 0x4000, v224
    v_add_u32 v249, 0x1000, v224
    v_add_u32 v252, 0x5000, v224
    v_bfe_u32 v2, v244, 2, 2
    v_and_b32 v3, 3, v244
    v_and_b32 v4, 1, v1
    s_lshl_b32 s41, s32, 13
    s_add_u32 s41, s41, 71808
    s_mov_b32 s14, 16384000
    s_mov_b32 s15, 0x00020000
    s_mov_b32 s30, 16384000
    s_mov_b32 s31, 0x00020000
    s_mov_b32 s18, 1310720
    s_mov_b32 s19, 0x00020000
    s_mov_b32 s22, 131072
    s_mov_b32 s23, 0x00020000
    s_mov_b32 s26, 16384000
    s_mov_b32 s27, 0x00020000
    s_cmp_eq_u32 s39, 1
    s_cselect_b32 s30, 0, s30
    s_waitcnt lgkmcnt(0)
    s_mov_b64 s[12:13], s[4:5]
    s_mov_b64 s[28:29], s[4:5]
    s_mov_b64 s[16:17], s[6:7]
    s_mov_b64 s[20:21], s[8:9]
    s_mov_b64 s[24:25], s[10:11]
    s_lshr_b32 s93, s2, 3
    s_cmp_eq_u32 s57, 0
    s_cbranch_scc1 L_hpro
    s_add_u32 m0, s48, 0
    s_add_u32 s38, s49, 0
    buffer_load_dwordx4 v234, s[28:31], s38 offen lds
    s_add_u32 m0, s48, 4224
    s_add_u32 s38, s49, 16384
    buffer_load_dwordx4 v234, s[12:15], s38 offen lds
    s_add_u32 m0, s48, 8448
    s_add_u32 s38, s49, 32768
    buffer_load_dwordx4 v234, s[12:15], s38 offen lds
    s_add_u32 m0, s48, 12672
    s_add_u32 s38, s49, 49152
    buffer_load_dwordx4 v234, s[12:15], s38 offen lds
    s_cmp_lg_u32 s32, 4
    s_cbranch_scc1 L_ppro
    s_add_u32 m0, s48, 16896
    s_add_u32 s38, s49, 65536
    buffer_load_dwordx4 v234, s[12:15], s38 offen lds
    s_branch L_ppro
L_hpro:
    s_mov_b32 s35, 0
    s_add_u32 m0, s41, 0
    s_nop 0
    buffer_load_dwordx4 v224, s[16:19], s35 offen lds
    s_add_u32 m0, s41, 1024
    s_nop 0
    buffer_load_dwordx4 v225, s[16:19], s35 offen lds
    s_add_u32 m0, s41, 2048
    s_nop 0
    buffer_load_dwordx4 v249, s[16:19], s35 offen lds
    s_add_u32 m0, s41, 3072
    s_nop 0
    buffer_load_dwordx4 v252, s[16:19], s35 offen lds
    s_mov_b32 s35, 262144
    s_add_u32 m0, s41, 4096
    s_nop 0
    buffer_load_dwordx4 v224, s[16:19], s35 offen lds
    s_add_u32 m0, s41, 5120
    s_nop 0
    buffer_load_dwordx4 v225, s[16:19], s35 offen lds
    s_add_u32 m0, s41, 6144
    s_nop 0
    buffer_load_dwordx4 v249, s[16:19], s35 offen lds
    s_add_u32 m0, s41, 7168
    s_nop 0
    buffer_load_dwordx4 v252, s[16:19], s35 offen lds
L_ppro:
    s_and_b32 s38, s32, 3
    s_and_b32 s36, s38, 1
    s_lshl_b32 s36, s36, 7
    s_lshr_b32 s37, s38, 1
    s_lshl_b32 s37, s37, 9
    s_add_u32 s36, s36, s37
    s_lshl_b32 s37, s57, 8
    s_add_u32 s36, s36, s37
    s_lshl_b32 s94, s93, 10
    s_add_u32 s94, s94, s36
    s_add_u32 s95, s94, 229376
    s_add_u32 s96, s94, 1048576
    s_cmp_ge_u32 s93, 2
    s_cselect_b32 s36, s95, s94
    s_buffer_load_dword s97, s[16:19], s36 offset:292864
    s_cmp_ge_u32 s93, 3
    s_cselect_b32 s36, s95, s94
    s_buffer_load_dword s97, s[16:19], s36 offset:553984
    s_cmp_ge_u32 s93, 4
    s_cselect_b32 s36, s95, s94
    s_buffer_load_dword s97, s[16:19], s36 offset:815104
    s_cmp_ge_u32 s93, 5
    s_cselect_b32 s36, s94, s96
    s_buffer_load_dword s97, s[16:19], s36 offset:27648
    s_cmp_ge_u32 s93, 6
    s_cselect_b32 s36, s95, s94
    s_buffer_load_dword s97, s[16:19], s36 offset:59392
    s_cmp_ge_u32 s93, 7
    s_cselect_b32 s36, s95, s94
    s_buffer_load_dword s97, s[16:19], s36 offset:320512
    s_cmp_ge_u32 s93, 8
    s_cselect_b32 s36, s95, s94
    s_buffer_load_dword s97, s[16:19], s36 offset:581632
    s_cmp_ge_u32 s93, 9
    s_cselect_b32 s36, s95, s94
    s_buffer_load_dword s97, s[16:19], s36 offset:842752
    s_cmp_ge_u32 s93, 10
    s_cselect_b32 s36, s94, s96
    s_buffer_load_dword s97, s[16:19], s36 offset:55296
    s_cmp_ge_u32 s93, 11
    s_cselect_b32 s36, s95, s94
    s_buffer_load_dword s97, s[16:19], s36 offset:87040
    s_cmp_ge_u32 s93, 12
    s_cselect_b32 s36, s95, s94
    s_buffer_load_dword s97, s[16:19], s36 offset:348160
    s_cmp_ge_u32 s93, 13
    s_cselect_b32 s36, s95, s94
    s_buffer_load_dword s97, s[16:19], s36 offset:609280
    s_add_u32 s36, s57, 1
    s_mul_i32 s37, s36, 17952
    s_add_u32 s48, s48, s37
    s_lshl_b32 s37, s36, 7
    s_add_u32 s49, s49, s37
    s_lshl_b32 s37, s36, 2
    s_add_u32 s37, s37, 161920
    v_mov_b32 v248, s37
    s_mov_b32 s45, 1
    s_cmp_eq_u32 s38, 0
    s_cselect_b32 s90, 1, 0
    s_lshl_b32 s36, s93, 13
    v_lshlrev_b32 v5, 7, v244
    v_add_u32 v247, s36, v5
    s_mov_b32 s42, 0xc038aa3b
    s_mov_b32 s43, 0xbfb8aa3b
    s_mov_b32 s44, 0x41f00000
    v_lshlrev_b32 v5, 9, v1
    v_lshl_add_u32 v5, v2, 7, v5
    v_lshl_add_u32 v6, v4, 6, v5
    v_lshrrev_b32 v7, 1, v2
    v_lshl_add_u32 v6, v7, 5, v6
    v_lshl_add_u32 v6, v3, 3, v6
    v_add_u32 v226, s41, v6
    v_xor_b32 v7, 32, v6
    v_add_u32 v227, s41, v7
    v_xor_b32 v7, 64, v6
    v_add_u32 v253, s41, v7
    v_xor_b32 v7, 96, v6
    v_add_u32 v254, s41, v7
    v_lshrrev_b32 v5, 1, v5
    s_and_b32 s38, s32, 3
    s_mul_i32 s56, s38, 6144
    s_add_u32 s56, s56, 137344
    v_lshl_add_u32 v6, v3, 4, v5
    v_add_u32 v232, s56, v6
    v_lshrrev_b32 v6, 2, v244
    v_lshlrev_b32 v6, 9, v6
    v_lshl_add_u32 v6, v3, 4, v6
    s_lshl_b32 s38, s38, 7
    v_add_u32 v231, s38, v6
    v_and_b32 v7, 15, v244
    s_mov_b32 s37, 1056
    v_mul_lo_u32 v5, v7, s37
    v_lshl_add_u32 v228, v1, 4, v5
    v_lshlrev_b32 v5, 12, v7
    v_lshl_add_u32 v5, v1, 4, v5
    v_add_u32 v233, s38, v5
    v_lshlrev_b32 v5, 4, v244
    v_add_u32 v229, 71808, v5
    v_add_u32 v230, s41, v5
    v_mov_b32 v239, 161920
    v_mov_b32 v235, 161924
    v_mov_b32 v237, 1
    s_cmp_lg_u32 s32, 4
    s_cbranch_scc1 L_nofl
    v_lshlrev_b32 v5, 2, v244
    v_add_u32 v5, 161920, v5
    v_cmp_eq_u32 vcc, 4, v244
    v_mov_b32 v6, 0
    s_nop 0
    v_cndmask_b32 v6, v6, v244, vcc
    ds_write_b32 v5, v6
L_nofl:
    s_lshl_b32 s36, s32, 2
    s_add_u32 s36, s36, 162048
    v_mov_b32 v242, s36
    s_and_b32 vcc_lo, s32, 1
    s_mov_b32 vcc_hi, 0
    v_mov_b32 v0, 0
    v_mov_b32 v1, 0
    v_mov_b32 v2, 0
    v_mov_b32 v3, 0
    v_mov_b32 v4, 0
    v_mov_b32 v5, 0
    v_mov_b32 v6, 0
    v_mov_b32 v7, 0
    v_mov_b32 v8, 0
    v_mov_b32 v9, 0
    v_mov_b32 v10, 0
    v_mov_b32 v11, 0
    v_mov_b32 v12, 0
    v_mov_b32 v13, 0
    v_mov_b32 v14, 0
    v_mov_b32 v15, 0
    v_mov_b32 v16, 0
    v_mov_b32 v17, 0
    v_mov_b32 v18, 0
    v_mov_b32 v19, 0
    v_mov_b32 v20, 0
    v_mov_b32 v21, 0
    v_mov_b32 v22, 0
    v_mov_b32 v23, 0
    v_mov_b32 v24, 0
    v_mov_b32 v25, 0
    v_mov_b32 v26, 0
    v_mov_b32 v27, 0
    v_mov_b32 v28, 0
    v_mov_b32 v29, 0
    v_mov_b32 v30, 0
    v_mov_b32 v31, 0
    v_mov_b32 v32, 0
    v_mov_b32 v33, 0
    v_mov_b32 v34, 0
    v_mov_b32 v35, 0
    v_mov_b32 v36, 0
    v_mov_b32 v37, 0
    v_mov_b32 v38, 0
    v_mov_b32 v39, 0
    v_mov_b32 v40, 0
    v_mov_b32 v41, 0
    v_mov_b32 v42, 0
    v_mov_b32 v43, 0
    v_mov_b32 v44, 0
    v_mov_b32 v45, 0
    v_mov_b32 v46, 0
    v_mov_b32 v47, 0
    v_mov_b32 v48, 0
    v_mov_b32 v49, 0
    v_mov_b32 v50, 0
    v_mov_b32 v51, 0
    v_mov_b32 v52, 0
    v_mov_b32 v53, 0
    v_mov_b32 v54, 0
    v_mov_b32 v55, 0
    v_mov_b32 v56, 0
    v_mov_b32 v57, 0
    v_mov_b32 v58, 0
    v_mov_b32 v59, 0
    v_mov_b32 v60, 0
    v_mov_b32 v61, 0
    v_mov_b32 v62, 0
    v_mov_b32 v63, 0
    v_mov_b32 v64, 0
    v_mov_b32 v65, 0
    v_mov_b32 v66, 0
    v_mov_b32 v67, 0
    v_mov_b32 v68, 0
    v_mov_b32 v69, 0
    v_mov_b32 v70, 0
    v_mov_b32 v71, 0
    v_mov_b32 v72, 0
    v_mov_b32 v73, 0
    v_mov_b32 v74, 0
    v_mov_b32 v75, 0
    v_mov_b32 v76, 0
    v_mov_b32 v77, 0
    v_mov_b32 v78, 0
    v_mov_b32 v79, 0
    v_mov_b32 v80, 0
    v_mov_b32 v81, 0
    v_mov_b32 v82, 0
    v_mov_b32 v83, 0
    v_mov_b32 v84, 0
    v_mov_b32 v85, 0
    v_mov_b32 v86, 0
    v_mov_b32 v87, 0
    v_mov_b32 v88, 0
    v_mov_b32 v89, 0
    v_mov_b32 v90, 0
    v_mov_b32 v91, 0
    v_mov_b32 v92, 0
    v_mov_b32 v93, 0
    v_mov_b32 v94, 0
    v_mov_b32 v95, 0
    v_mov_b32 v96, 0
    v_mov_b32 v97, 0
    v_mov_b32 v98, 0
    v_mov_b32 v99, 0
    v_mov_b32 v100, 0
    v_mov_b32 v101, 0
    v_mov_b32 v102, 0
    v_mov_b32 v103, 0
    v_mov_b32 v104, 0
    v_mov_b32 v105, 0
    v_mov_b32 v106, 0
    v_mov_b32 v107, 0
    v_mov_b32 v108, 0
    v_mov_b32 v109, 0
    v_mov_b32 v110, 0
    v_mov_b32 v111, 0
    v_mov_b32 v112, 0
    v_mov_b32 v113, 0
    v_mov_b32 v114, 0
    v_mov_b32 v115, 0
    v_mov_b32 v116, 0
    v_mov_b32 v117, 0
    v_mov_b32 v118, 0
    v_mov_b32 v119, 0
    v_mov_b32 v120, 0
    v_mov_b32 v121, 0
    v_mov_b32 v122, 0
    v_mov_b32 v123, 0
    v_mov_b32 v124, 0
    v_mov_b32 v125, 0
    v_mov_b32 v126, 0
    v_mov_b32 v127, 0
    s_mov_b32 s33, 0
    s_mov_b32 s34, 0
    s_setprio 3
    s_cmp_eq_u32 s57, 0
    s_cbranch_scc1 L_hw
    s_mov_b32 s35, 0
    s_add_u32 m0, s41, 0
    s_nop 0
    buffer_load_dwordx4 v224, s[16:19], s35 offen lds
    s_add_u32 m0, s41, 1024
    s_nop 0
    buffer_load_dwordx4 v225, s[16:19], s35 offen lds
    s_add_u32 m0, s41, 2048
    s_nop 0
    buffer_load_dwordx4 v249, s[16:19], s35 offen lds
    s_add_u32 m0, s41, 3072
    s_nop 0
    buffer_load_dwordx4 v252, s[16:19], s35 offen lds
    s_waitcnt vmcnt(4) lgkmcnt(0)
    s_barrier
    s_mov_b32 s35, 262144
    s_add_u32 m0, s41, 4096
    s_nop 0
    buffer_load_dwordx4 v224, s[16:19], s35 offen lds
    s_add_u32 m0, s41, 5120
    s_nop 0
    buffer_load_dwordx4 v225, s[16:19], s35 offen lds
    s_add_u32 m0, s41, 6144
    s_nop 0
    buffer_load_dwordx4 v249, s[16:19], s35 offen lds
    s_add_u32 m0, s41, 7168
    s_nop 0
    buffer_load_dwordx4 v252, s[16:19], s35 offen lds
    s_add_u32 s35, s33, 524288
    s_waitcnt vmcnt(6)
    ds_read_b64_tr_b16 v[160:161], v226 offset:0
    ds_read_b64_tr_b16 v[164:165], v227 offset:0
    ds_read_b64_tr_b16 v[168:169], v253 offset:0
    ds_read_b64_tr_b16 v[172:173], v254 offset:0
    s_waitcnt vmcnt(4)
    ds_read_b64_tr_b16 v[162:163], v226 offset:2048
    ds_read_b64_tr_b16 v[166:167], v227 offset:2048
    ds_read_b64_tr_b16 v[170:171], v253 offset:2048
    ds_read_b64_tr_b16 v[174:175], v254 offset:2048
    s_add_u32 m0, s41, 0
    s_waitcnt lgkmcnt(4)
    s_nop 0
    buffer_load_dwordx4 v224, s[16:19], s35 offen lds
    s_add_u32 m0, s41, 1024
    s_nop 0
    buffer_load_dwordx4 v225, s[16:19], s35 offen lds
    s_add_u32 m0, s41, 2048
    s_waitcnt lgkmcnt(0)
    s_nop 0
    buffer_load_dwordx4 v249, s[16:19], s35 offen lds
    s_add_u32 m0, s41, 3072
    s_nop 0
    buffer_load_dwordx4 v252, s[16:19], s35 offen lds
    s_branch L_bar
L_hw:
    s_add_u32 s35, s33, 524288
    s_waitcnt vmcnt(6)
    ds_read_b64_tr_b16 v[160:161], v226 offset:0
    ds_read_b64_tr_b16 v[164:165], v227 offset:0
    ds_read_b64_tr_b16 v[168:169], v253 offset:0
    ds_read_b64_tr_b16 v[172:173], v254 offset:0
    s_waitcnt vmcnt(4)
    ds_read_b64_tr_b16 v[162:163], v226 offset:2048
    ds_read_b64_tr_b16 v[166:167], v227 offset:2048
    ds_read_b64_tr_b16 v[170:171], v253 offset:2048
    ds_read_b64_tr_b16 v[174:175], v254 offset:2048
    s_add_u32 m0, s41, 0
    s_waitcnt lgkmcnt(4)
    s_nop 0
    buffer_load_dwordx4 v224, s[16:19], s35 offen lds
    s_add_u32 m0, s41, 1024
    s_nop 0
    buffer_load_dwordx4 v225, s[16:19], s35 offen lds
    s_add_u32 m0, s41, 2048
    s_waitcnt lgkmcnt(0)
    s_nop 0
    buffer_load_dwordx4 v249, s[16:19], s35 offen lds
    s_add_u32 m0, s41, 3072
    s_nop 0
    buffer_load_dwordx4 v252, s[16:19], s35 offen lds
    s_barrier
L_bar:
    ds_read_b128 v[156:159], v228 offset:1952
    ds_read_b128 v[152:155], v228 offset:1824
    ds_read_b128 v[148:151], v228 offset:1696
    ds_read_b128 v[144:147], v228 offset:1568
    ds_read_b128 v[140:143], v228 offset:1440
    ds_read_b128 v[136:139], v228 offset:1312
    ds_read_b128 v[132:135], v228 offset:1184
    ds_read_b128 v[128:131], v228 offset:1056
    s_waitcnt lgkmcnt(6)
L_loop:
    v_mfma_f32_16x16x32_bf16 v[112:115], v[160:163], v[156:159], v[112:115]
    s_add_u32 s35, s33, 786432
    s_waitcnt vmcnt(6)
    ds_read_b64_tr_b16 v[176:177], v226 offset:4096
    ds_read_b64_tr_b16 v[180:181], v227 offset:4096
    ds_read_b64_tr_b16 v[184:185], v253 offset:4096
    ds_read_b64_tr_b16 v[188:189], v254 offset:4096
    v_mfma_f32_16x16x32_bf16 v[116:119], v[164:167], v[156:159], v[116:119]
    v_mfma_f32_16x16x32_bf16 v[120:123], v[168:171], v[156:159], v[120:123]
    s_cmp_eq_u32 s45, 0
    s_cbranch_scc1 L_hx0
    s_add_u32 m0, s48, 0
    s_add_u32 s38, s49, 0
    buffer_load_dwordx4 v234, s[28:31], s38 offen lds
L_hx0:
    v_mfma_f32_16x16x32_bf16 v[124:127], v[172:175], v[156:159], v[124:127]
    ds_read_b128 v[156:159], v228 offset:896
    v_mfma_f32_16x16x32_bf16 v[96:99], v[160:163], v[152:155], v[96:99]
    v_mfma_f32_16x16x32_bf16 v[100:103], v[164:167], v[152:155], v[100:103]
    v_mfma_f32_16x16x32_bf16 v[104:107], v[168:171], v[152:155], v[104:107]
    s_add_u32 m0, s41, 4096
    v_mfma_f32_16x16x32_bf16 v[108:111], v[172:175], v[152:155], v[108:111]
    ds_read_b128 v[152:155], v228 offset:768
    s_waitcnt lgkmcnt(2)
    buffer_load_dwordx4 v224, s[16:19], s35 offen lds
    v_mfma_f32_16x16x32_bf16 v[80:83], v[160:163], v[148:151], v[80:83]
    s_add_u32 m0, s41, 5120
    v_mfma_f32_16x16x32_bf16 v[84:87], v[164:167], v[148:151], v[84:87]
    buffer_load_dwordx4 v225, s[16:19], s35 offen lds
    v_mfma_f32_16x16x32_bf16 v[88:91], v[168:171], v[148:151], v[88:91]
    v_mfma_f32_16x16x32_bf16 v[92:95], v[172:175], v[148:151], v[92:95]
    v_mfma_f32_16x16x32_bf16 v[64:67], v[160:163], v[144:147], v[64:67]
    v_mfma_f32_16x16x32_bf16 v[68:71], v[164:167], v[144:147], v[68:71]
    v_mfma_f32_16x16x32_bf16 v[72:75], v[168:171], v[144:147], v[72:75]
    v_mfma_f32_16x16x32_bf16 v[76:79], v[172:175], v[144:147], v[76:79]
    v_mfma_f32_16x16x32_bf16 v[48:51], v[160:163], v[140:143], v[48:51]
    s_waitcnt vmcnt(6)
    ds_read_b64_tr_b16 v[178:179], v226 offset:6144
    ds_read_b64_tr_b16 v[182:183], v227 offset:6144
    ds_read_b64_tr_b16 v[186:187], v253 offset:6144
    ds_read_b64_tr_b16 v[190:191], v254 offset:6144
    v_mfma_f32_16x16x32_bf16 v[52:55], v[164:167], v[140:143], v[52:55]
    v_mfma_f32_16x16x32_bf16 v[56:59], v[168:171], v[140:143], v[56:59]
    v_mfma_f32_16x16x32_bf16 v[60:63], v[172:175], v[140:143], v[60:63]
    v_mfma_f32_16x16x32_bf16 v[32:35], v[160:163], v[136:139], v[32:35]
    v_mfma_f32_16x16x32_bf16 v[36:39], v[164:167], v[136:139], v[36:39]
    v_mfma_f32_16x16x32_bf16 v[40:43], v[168:171], v[136:139], v[40:43]
    s_add_u32 m0, s41, 6144
    v_mfma_f32_16x16x32_bf16 v[44:47], v[172:175], v[136:139], v[44:47]
    s_waitcnt lgkmcnt(0)
    buffer_load_dwordx4 v249, s[16:19], s35 offen lds
    v_mfma_f32_16x16x32_bf16 v[16:19], v[160:163], v[132:135], v[16:19]
    s_add_u32 m0, s41, 7168
    v_mfma_f32_16x16x32_bf16 v[20:23], v[164:167], v[132:135], v[20:23]
    buffer_load_dwordx4 v252, s[16:19], s35 offen lds
    v_mfma_f32_16x16x32_bf16 v[24:27], v[168:171], v[132:135], v[24:27]
    v_mfma_f32_16x16x32_bf16 v[28:31], v[172:175], v[132:135], v[28:31]
    v_mfma_f32_16x16x32_bf16 v[0:3], v[160:163], v[128:131], v[0:3]
    v_mfma_f32_16x16x32_bf16 v[4:7], v[164:167], v[128:131], v[4:7]
    v_mfma_f32_16x16x32_bf16 v[8:11], v[168:171], v[128:131], v[8:11]
    v_mfma_f32_16x16x32_bf16 v[12:15], v[172:175], v[128:131], v[12:15]
    v_mfma_f32_16x16x32_bf16 v[112:115], v[176:179], v[148:151], v[112:115]
    s_add_u32 s35, s33, 1048576
    s_waitcnt vmcnt(6)
    ds_read_b64_tr_b16 v[160:161], v226 offset:0
    ds_read_b64_tr_b16 v[164:165], v227 offset:0
    ds_read_b64_tr_b16 v[168:169], v253 offset:0
    ds_read_b64_tr_b16 v[172:173], v254 offset:0
    v_mfma_f32_16x16x32_bf16 v[116:119], v[180:183], v[148:151], v[116:119]
    v_mfma_f32_16x16x32_bf16 v[120:123], v[184:187], v[148:151], v[120:123]
    s_cmp_eq_u32 s45, 0
    s_cbranch_scc1 L_hx1
    s_add_u32 m0, s48, 4224
    s_add_u32 s38, s49, 16384
    buffer_load_dwordx4 v234, s[12:15], s38 offen lds
L_hx1:
    v_mfma_f32_16x16x32_bf16 v[124:127], v[188:191], v[148:151], v[124:127]
    ds_read_b128 v[148:151], v228 offset:640
    v_mfma_f32_16x16x32_bf16 v[96:99], v[176:179], v[144:147], v[96:99]
    v_mfma_f32_16x16x32_bf16 v[100:103], v[180:183], v[144:147], v[100:103]
    v_mfma_f32_16x16x32_bf16 v[104:107], v[184:187], v[144:147], v[104:107]
    s_add_u32 m0, s41, 0
    v_mfma_f32_16x16x32_bf16 v[108:111], v[188:191], v[144:147], v[108:111]
    ds_read_b128 v[144:147], v228 offset:512
    s_waitcnt lgkmcnt(2)
    buffer_load_dwordx4 v224, s[16:19], s35 offen lds
    v_mfma_f32_16x16x32_bf16 v[80:83], v[176:179], v[140:143], v[80:83]
    s_add_u32 m0, s41, 1024
    v_mfma_f32_16x16x32_bf16 v[84:87], v[180:183], v[140:143], v[84:87]
    buffer_load_dwordx4 v225, s[16:19], s35 offen lds
    v_mfma_f32_16x16x32_bf16 v[88:91], v[184:187], v[140:143], v[88:91]
    v_mfma_f32_16x16x32_bf16 v[92:95], v[188:191], v[140:143], v[92:95]
    v_mfma_f32_16x16x32_bf16 v[64:67], v[176:179], v[136:139], v[64:67]
    v_mfma_f32_16x16x32_bf16 v[68:71], v[180:183], v[136:139], v[68:71]
    v_mfma_f32_16x16x32_bf16 v[72:75], v[184:187], v[136:139], v[72:75]
    v_mfma_f32_16x16x32_bf16 v[76:79], v[188:191], v[136:139], v[76:79]
    v_mfma_f32_16x16x32_bf16 v[48:51], v[176:179], v[132:135], v[48:51]
    s_waitcnt vmcnt(6)
    ds_read_b64_tr_b16 v[162:163], v226 offset:2048
    ds_read_b64_tr_b16 v[166:167], v227 offset:2048
    ds_read_b64_tr_b16 v[170:171], v253 offset:2048
    ds_read_b64_tr_b16 v[174:175], v254 offset:2048
    v_mfma_f32_16x16x32_bf16 v[52:55], v[180:183], v[132:135], v[52:55]
    v_mfma_f32_16x16x32_bf16 v[56:59], v[184:187], v[132:135], v[56:59]
    v_mfma_f32_16x16x32_bf16 v[60:63], v[188:191], v[132:135], v[60:63]
    v_mfma_f32_16x16x32_bf16 v[32:35], v[176:179], v[128:131], v[32:35]
    v_mfma_f32_16x16x32_bf16 v[36:39], v[180:183], v[128:131], v[36:39]
    v_mfma_f32_16x16x32_bf16 v[40:43], v[184:187], v[128:131], v[40:43]
    s_add_u32 m0, s41, 2048
    v_mfma_f32_16x16x32_bf16 v[44:47], v[188:191], v[128:131], v[44:47]
    s_waitcnt lgkmcnt(0)
    buffer_load_dwordx4 v249, s[16:19], s35 offen lds
    v_mfma_f32_16x16x32_bf16 v[16:19], v[176:179], v[156:159], v[16:19]
    s_add_u32 m0, s41, 3072
    v_mfma_f32_16x16x32_bf16 v[20:23], v[180:183], v[156:159], v[20:23]
    buffer_load_dwordx4 v252, s[16:19], s35 offen lds
    v_mfma_f32_16x16x32_bf16 v[24:27], v[184:187], v[156:159], v[24:27]
    v_mfma_f32_16x16x32_bf16 v[28:31], v[188:191], v[156:159], v[28:31]
    v_mfma_f32_16x16x32_bf16 v[0:3], v[176:179], v[152:155], v[0:3]
    v_mfma_f32_16x16x32_bf16 v[4:7], v[180:183], v[152:155], v[4:7]
    v_mfma_f32_16x16x32_bf16 v[8:11], v[184:187], v[152:155], v[8:11]
    v_mfma_f32_16x16x32_bf16 v[12:15], v[188:191], v[152:155], v[12:15]
    v_mfma_f32_16x16x32_bf16 v[112:115], v[160:163], v[140:143], v[112:115]
    s_add_u32 s35, s33, 32768
    s_waitcnt vmcnt(6)
    ds_read_b64_tr_b16 v[176:177], v226 offset:4096
    ds_read_b64_tr_b16 v[180:181], v227 offset:4096
    ds_read_b64_tr_b16 v[184:185], v253 offset:4096
    ds_read_b64_tr_b16 v[188:189], v254 offset:4096
    v_mfma_f32_16x16x32_bf16 v[116:119], v[164:167], v[140:143], v[116:119]
    v_mfma_f32_16x16x32_bf16 v[120:123], v[168:171], v[140:143], v[120:123]
    s_cmp_eq_u32 s45, 0
    s_cbranch_scc1 L_hx2
    s_add_u32 m0, s48, 8448
    s_add_u32 s38, s49, 32768
    buffer_load_dwordx4 v234, s[12:15], s38 offen lds
L_hx2:
    v_mfma_f32_16x16x32_bf16 v[124:127], v[172:175], v[140:143], v[124:127]
    ds_read_b128 v[140:143], v228 offset:384
    v_mfma_f32_16x16x32_bf16 v[96:99], v[160:163], v[136:139], v[96:99]
    v_mfma_f32_16x16x32_bf16 v[100:103], v[164:167], v[136:139], v[100:103]
    v_mfma_f32_16x16x32_bf16 v[104:107], v[168:171], v[136:139], v[104:107]
    s_add_u32 m0, s41, 4096
    v_mfma_f32_16x16x32_bf16 v[108:111], v[172:175], v[136:139], v[108:111]
    ds_read_b128 v[136:139], v228 offset:256
    s_waitcnt lgkmcnt(2)
    buffer_load_dwordx4 v224, s[16:19], s35 offen lds
    v_mfma_f32_16x16x32_bf16 v[80:83], v[160:163], v[132:135], v[80:83]
    s_add_u32 m0, s41, 5120
    v_mfma_f32_16x16x32_bf16 v[84:87], v[164:167], v[132:135], v[84:87]
    buffer_load_dwordx4 v225, s[16:19], s35 offen lds
    v_mfma_f32_16x16x32_bf16 v[88:91], v[168:171], v[132:135], v[88:91]
    v_mfma_f32_16x16x32_bf16 v[92:95], v[172:175], v[132:135], v[92:95]
    v_mfma_f32_16x16x32_bf16 v[64:67], v[160:163], v[128:131], v[64:67]
    v_mfma_f32_16x16x32_bf16 v[68:71], v[164:167], v[128:131], v[68:71]
    v_mfma_f32_16x16x32_bf16 v[72:75], v[168:171], v[128:131], v[72:75]
    v_mfma_f32_16x16x32_bf16 v[76:79], v[172:175], v[128:131], v[76:79]
    v_mfma_f32_16x16x32_bf16 v[48:51], v[160:163], v[156:159], v[48:51]
    s_waitcnt vmcnt(6)
    ds_read_b64_tr_b16 v[178:179], v226 offset:6144
    ds_read_b64_tr_b16 v[182:183], v227 offset:6144
    ds_read_b64_tr_b16 v[186:187], v253 offset:6144
    ds_read_b64_tr_b16 v[190:191], v254 offset:6144
    v_mfma_f32_16x16x32_bf16 v[52:55], v[164:167], v[156:159], v[52:55]
    v_mfma_f32_16x16x32_bf16 v[56:59], v[168:171], v[156:159], v[56:59]
    v_mfma_f32_16x16x32_bf16 v[60:63], v[172:175], v[156:159], v[60:63]
    v_mfma_f32_16x16x32_bf16 v[32:35], v[160:163], v[152:155], v[32:35]
    v_mfma_f32_16x16x32_bf16 v[36:39], v[164:167], v[152:155], v[36:39]
    v_mfma_f32_16x16x32_bf16 v[40:43], v[168:171], v[152:155], v[40:43]
    s_add_u32 m0, s41, 6144
    v_mfma_f32_16x16x32_bf16 v[44:47], v[172:175], v[152:155], v[44:47]
    s_waitcnt lgkmcnt(0)
    buffer_load_dwordx4 v249, s[16:19], s35 offen lds
    v_mfma_f32_16x16x32_bf16 v[16:19], v[160:163], v[148:151], v[16:19]
    s_add_u32 m0, s41, 7168
    v_mfma_f32_16x16x32_bf16 v[20:23], v[164:167], v[148:151], v[20:23]
    buffer_load_dwordx4 v252, s[16:19], s35 offen lds
    v_mfma_f32_16x16x32_bf16 v[24:27], v[168:171], v[148:151], v[24:27]
    v_mfma_f32_16x16x32_bf16 v[28:31], v[172:175], v[148:151], v[28:31]
    v_mfma_f32_16x16x32_bf16 v[0:3], v[160:163], v[144:147], v[0:3]
    v_mfma_f32_16x16x32_bf16 v[4:7], v[164:167], v[144:147], v[4:7]
    v_mfma_f32_16x16x32_bf16 v[8:11], v[168:171], v[144:147], v[8:11]
    v_mfma_f32_16x16x32_bf16 v[12:15], v[172:175], v[144:147], v[12:15]
    v_mfma_f32_16x16x32_bf16 v[112:115], v[176:179], v[132:135], v[112:115]
    s_add_u32 s35, s33, 294912
    s_waitcnt vmcnt(6)
    ds_read_b64_tr_b16 v[160:161], v226 offset:0
    ds_read_b64_tr_b16 v[164:165], v227 offset:0
    ds_read_b64_tr_b16 v[168:169], v253 offset:0
    ds_read_b64_tr_b16 v[172:173], v254 offset:0
    v_mfma_f32_16x16x32_bf16 v[116:119], v[180:183], v[132:135], v[116:119]
    v_mfma_f32_16x16x32_bf16 v[120:123], v[184:187], v[132:135], v[120:123]
    s_cmp_eq_u32 s45, 0
    s_cbranch_scc1 L_hx3
    s_add_u32 m0, s48, 12672
    s_add_u32 s38, s49, 49152
    buffer_load_dwordx4 v234, s[12:15], s38 offen lds
L_hx3:
    v_mfma_f32_16x16x32_bf16 v[124:127], v[188:191], v[132:135], v[124:127]
    ds_read_b128 v[132:135], v228 offset:128
    v_mfma_f32_16x16x32_bf16 v[96:99], v[176:179], v[128:131], v[96:99]
    v_mfma_f32_16x16x32_bf16 v[100:103], v[180:183], v[128:131], v[100:103]
    v_mfma_f32_16x16x32_bf16 v[104:107], v[184:187], v[128:131], v[104:107]
    s_add_u32 m0, s41, 0
    v_mfma_f32_16x16x32_bf16 v[108:111], v[188:191], v[128:131], v[108:111]
    ds_read_b128 v[128:131], v228 offset:0
    s_waitcnt lgkmcnt(2)
    buffer_load_dwordx4 v224, s[16:19], s35 offen lds
    v_mfma_f32_16x16x32_bf16 v[80:83], v[176:179], v[156:159], v[80:83]
    s_add_u32 m0, s41, 1024
    v_mfma_f32_16x16x32_bf16 v[84:87], v[180:183], v[156:159], v[84:87]
    buffer_load_dwordx4 v225, s[16:19], s35 offen lds
    v_mfma_f32_16x16x32_bf16 v[88:91], v[184:187], v[156:159], v[88:91]
    v_mfma_f32_16x16x32_bf16 v[92:95], v[188:191], v[156:159], v[92:95]
    v_mfma_f32_16x16x32_bf16 v[64:67], v[176:179], v[152:155], v[64:67]
    v_mfma_f32_16x16x32_bf16 v[68:71], v[180:183], v[152:155], v[68:71]
    v_mfma_f32_16x16x32_bf16 v[72:75], v[184:187], v[152:155], v[72:75]
    v_mfma_f32_16x16x32_bf16 v[76:79], v[188:191], v[152:155], v[76:79]
    v_mfma_f32_16x16x32_bf16 v[48:51], v[176:179], v[148:151], v[48:51]
    s_waitcnt vmcnt(6)
    ds_read_b64_tr_b16 v[162:163], v226 offset:2048
    ds_read_b64_tr_b16 v[166:167], v227 offset:2048
    ds_read_b64_tr_b16 v[170:171], v253 offset:2048
    ds_read_b64_tr_b16 v[174:175], v254 offset:2048
    v_mfma_f32_16x16x32_bf16 v[52:55], v[180:183], v[148:151], v[52:55]
    v_mfma_f32_16x16x32_bf16 v[56:59], v[184:187], v[148:151], v[56:59]
    v_mfma_f32_16x16x32_bf16 v[60:63], v[188:191], v[148:151], v[60:63]
    v_mfma_f32_16x16x32_bf16 v[32:35], v[176:179], v[144:147], v[32:35]
    v_mfma_f32_16x16x32_bf16 v[36:39], v[180:183], v[144:147], v[36:39]
    v_mfma_f32_16x16x32_bf16 v[40:43], v[184:187], v[144:147], v[40:43]
    s_add_u32 m0, s41, 2048
    v_mfma_f32_16x16x32_bf16 v[44:47], v[188:191], v[144:147], v[44:47]
    s_waitcnt lgkmcnt(0)
    buffer_load_dwordx4 v249, s[16:19], s35 offen lds
    v_mfma_f32_16x16x32_bf16 v[16:19], v[176:179], v[140:143], v[16:19]
    s_add_u32 m0, s41, 3072
    v_mfma_f32_16x16x32_bf16 v[20:23], v[180:183], v[140:143], v[20:23]
    buffer_load_dwordx4 v252, s[16:19], s35 offen lds
    v_mfma_f32_16x16x32_bf16 v[24:27], v[184:187], v[140:143], v[24:27]
    v_mfma_f32_16x16x32_bf16 v[28:31], v[188:191], v[140:143], v[28:31]
    v_mfma_f32_16x16x32_bf16 v[0:3], v[176:179], v[136:139], v[0:3]
    v_mfma_f32_16x16x32_bf16 v[4:7], v[180:183], v[136:139], v[4:7]
    v_mfma_f32_16x16x32_bf16 v[8:11], v[184:187], v[136:139], v[8:11]
    v_mfma_f32_16x16x32_bf16 v[12:15], v[188:191], v[136:139], v[12:15]
    v_mfma_f32_16x16x32_bf16 v[112:115], v[160:163], v[156:159], v[112:115]
    s_add_u32 s35, s33, 557056
    s_waitcnt vmcnt(6)
    ds_read_b64_tr_b16 v[176:177], v226 offset:4096
    ds_read_b64_tr_b16 v[180:181], v227 offset:4096
    ds_read_b64_tr_b16 v[184:185], v253 offset:4096
    ds_read_b64_tr_b16 v[188:189], v254 offset:4096
    v_mfma_f32_16x16x32_bf16 v[116:119], v[164:167], v[156:159], v[116:119]
    v_mfma_f32_16x16x32_bf16 v[120:123], v[168:171], v[156:159], v[120:123]
    s_cmp_eq_u32 s90, 0
    s_cbranch_scc1 L_hx4
    s_add_u32 m0, s48, 16896
    s_add_u32 s38, s49, 65536
    buffer_load_dwordx4 v234, s[12:15], s38 offen lds
L_hx4:
    v_mfma_f32_16x16x32_bf16 v[124:127], v[172:175], v[156:159], v[124:127]
    ds_read_b128 v[156:159], v228 offset:2016
    v_mfma_f32_16x16x32_bf16 v[96:99], v[160:163], v[152:155], v[96:99]
    v_mfma_f32_16x16x32_bf16 v[100:103], v[164:167], v[152:155], v[100:103]
    v_mfma_f32_16x16x32_bf16 v[104:107], v[168:171], v[152:155], v[104:107]
    s_add_u32 m0, s41, 4096
    v_mfma_f32_16x16x32_bf16 v[108:111], v[172:175], v[152:155], v[108:111]
    ds_read_b128 v[152:155], v228 offset:1888
    s_waitcnt lgkmcnt(2)
    buffer_load_dwordx4 v224, s[16:19], s35 offen lds
    v_mfma_f32_16x16x32_bf16 v[80:83], v[160:163], v[148:151], v[80:83]
    s_add_u32 m0, s41, 5120
    v_mfma_f32_16x16x32_bf16 v[84:87], v[164:167], v[148:151], v[84:87]
    buffer_load_dwordx4 v225, s[16:19], s35 offen lds
    v_mfma_f32_16x16x32_bf16 v[88:91], v[168:171], v[148:151], v[88:91]
    v_mfma_f32_16x16x32_bf16 v[92:95], v[172:175], v[148:151], v[92:95]
    ds_read_b128 v[148:151], v228 offset:1760
    v_mfma_f32_16x16x32_bf16 v[64:67], v[160:163], v[144:147], v[64:67]
    v_mfma_f32_16x16x32_bf16 v[68:71], v[164:167], v[144:147], v[68:71]
    v_mfma_f32_16x16x32_bf16 v[72:75], v[168:171], v[144:147], v[72:75]
    v_mfma_f32_16x16x32_bf16 v[76:79], v[172:175], v[144:147], v[76:79]
    ds_read_b128 v[144:147], v228 offset:1632
    v_mfma_f32_16x16x32_bf16 v[48:51], v[160:163], v[140:143], v[48:51]
    s_waitcnt vmcnt(6)
    ds_read_b64_tr_b16 v[178:179], v226 offset:6144
    ds_read_b64_tr_b16 v[182:183], v227 offset:6144
    ds_read_b64_tr_b16 v[186:187], v253 offset:6144
    ds_read_b64_tr_b16 v[190:191], v254 offset:6144
    v_mfma_f32_16x16x32_bf16 v[52:55], v[164:167], v[140:143], v[52:55]
    v_mfma_f32_16x16x32_bf16 v[56:59], v[168:171], v[140:143], v[56:59]
    v_mfma_f32_16x16x32_bf16 v[60:63], v[172:175], v[140:143], v[60:63]
    ds_read_b128 v[140:143], v228 offset:1504
    v_mfma_f32_16x16x32_bf16 v[32:35], v[160:163], v[136:139], v[32:35]
    v_mfma_f32_16x16x32_bf16 v[36:39], v[164:167], v[136:139], v[36:39]
    v_mfma_f32_16x16x32_bf16 v[40:43], v[168:171], v[136:139], v[40:43]
    s_add_u32 m0, s41, 6144
    v_mfma_f32_16x16x32_bf16 v[44:47], v[172:175], v[136:139], v[44:47]
    ds_read_b128 v[136:139], v228 offset:1376
    s_waitcnt lgkmcnt(2)
    buffer_load_dwordx4 v249, s[16:19], s35 offen lds
    v_mfma_f32_16x16x32_bf16 v[16:19], v[160:163], v[132:135], v[16:19]
    s_add_u32 m0, s41, 7168
    v_mfma_f32_16x16x32_bf16 v[20:23], v[164:167], v[132:135], v[20:23]
    buffer_load_dwordx4 v252, s[16:19], s35 offen lds
    v_mfma_f32_16x16x32_bf16 v[24:27], v[168:171], v[132:135], v[24:27]
    v_mfma_f32_16x16x32_bf16 v[28:31], v[172:175], v[132:135], v[28:31]
    ds_read_b128 v[132:135], v228 offset:1248
    v_mfma_f32_16x16x32_bf16 v[0:3], v[160:163], v[128:131], v[0:3]
    v_mfma_f32_16x16x32_bf16 v[4:7], v[164:167], v[128:131], v[4:7]
    v_mfma_f32_16x16x32_bf16 v[8:11], v[168:171], v[128:131], v[8:11]
    v_mfma_f32_16x16x32_bf16 v[12:15], v[172:175], v[128:131], v[12:15]
    ds_read_b128 v[128:131], v228 offset:1120
    v_mfma_f32_16x16x32_bf16 v[112:115], v[176:179], v[156:159], v[112:115]
    s_add_u32 s35, s33, 819200
    s_waitcnt vmcnt(6)
    ds_read_b64_tr_b16 v[160:161], v226 offset:0
    ds_read_b64_tr_b16 v[164:165], v227 offset:0
    ds_read_b64_tr_b16 v[168:169], v253 offset:0
    ds_read_b64_tr_b16 v[172:173], v254 offset:0
    v_mfma_f32_16x16x32_bf16 v[116:119], v[180:183], v[156:159], v[116:119]
    v_mfma_f32_16x16x32_bf16 v[120:123], v[184:187], v[156:159], v[120:123]
    v_mfma_f32_16x16x32_bf16 v[124:127], v[188:191], v[156:159], v[124:127]
    ds_read_b128 v[156:159], v228 offset:960
    v_mfma_f32_16x16x32_bf16 v[96:99], v[176:179], v[152:155], v[96:99]
    v_mfma_f32_16x16x32_bf16 v[100:103], v[180:183], v[152:155], v[100:103]
    v_mfma_f32_16x16x32_bf16 v[104:107], v[184:187], v[152:155], v[104:107]
    s_add_u32 m0, s41, 0
    v_mfma_f32_16x16x32_bf16 v[108:111], v[188:191], v[152:155], v[108:111]
    ds_read_b128 v[152:155], v228 offset:832
    s_waitcnt lgkmcnt(2)
    buffer_load_dwordx4 v224, s[16:19], s35 offen lds
    v_mfma_f32_16x16x32_bf16 v[80:83], v[176:179], v[148:151], v[80:83]
    s_add_u32 m0, s41, 1024
    v_mfma_f32_16x16x32_bf16 v[84:87], v[180:183], v[148:151], v[84:87]
    buffer_load_dwordx4 v225, s[16:19], s35 offen lds
    v_mfma_f32_16x16x32_bf16 v[88:91], v[184:187], v[148:151], v[88:91]
    v_mfma_f32_16x16x32_bf16 v[92:95], v[188:191], v[148:151], v[92:95]
    v_mfma_f32_16x16x32_bf16 v[64:67], v[176:179], v[144:147], v[64:67]
    v_mfma_f32_16x16x32_bf16 v[68:71], v[180:183], v[144:147], v[68:71]
    v_mfma_f32_16x16x32_bf16 v[72:75], v[184:187], v[144:147], v[72:75]
    v_mfma_f32_16x16x32_bf16 v[76:79], v[188:191], v[144:147], v[76:79]
    v_mfma_f32_16x16x32_bf16 v[48:51], v[176:179], v[140:143], v[48:51]
    s_waitcnt vmcnt(6)
    ds_read_b64_tr_b16 v[162:163], v226 offset:2048
    ds_read_b64_tr_b16 v[166:167], v227 offset:2048
    ds_read_b64_tr_b16 v[170:171], v253 offset:2048
    ds_read_b64_tr_b16 v[174:175], v254 offset:2048
    v_mfma_f32_16x16x32_bf16 v[52:55], v[180:183], v[140:143], v[52:55]
    v_mfma_f32_16x16x32_bf16 v[56:59], v[184:187], v[140:143], v[56:59]
    v_mfma_f32_16x16x32_bf16 v[60:63], v[188:191], v[140:143], v[60:63]
    v_mfma_f32_16x16x32_bf16 v[32:35], v[176:179], v[136:139], v[32:35]
    v_mfma_f32_16x16x32_bf16 v[36:39], v[180:183], v[136:139], v[36:39]
    v_mfma_f32_16x16x32_bf16 v[40:43], v[184:187], v[136:139], v[40:43]
    s_add_u32 m0, s41, 2048
    v_mfma_f32_16x16x32_bf16 v[44:47], v[188:191], v[136:139], v[44:47]
    s_waitcnt lgkmcnt(0)
    buffer_load_dwordx4 v249, s[16:19], s35 offen lds
    v_mfma_f32_16x16x32_bf16 v[16:19], v[176:179], v[132:135], v[16:19]
    s_add_u32 m0, s41, 3072
    v_mfma_f32_16x16x32_bf16 v[20:23], v[180:183], v[132:135], v[20:23]
    buffer_load_dwordx4 v252, s[16:19], s35 offen lds
    v_mfma_f32_16x16x32_bf16 v[24:27], v[184:187], v[132:135], v[24:27]
    v_mfma_f32_16x16x32_bf16 v[28:31], v[188:191], v[132:135], v[28:31]
    v_mfma_f32_16x16x32_bf16 v[0:3], v[176:179], v[128:131], v[0:3]
    v_mfma_f32_16x16x32_bf16 v[4:7], v[180:183], v[128:131], v[4:7]
    v_mfma_f32_16x16x32_bf16 v[8:11], v[184:187], v[128:131], v[8:11]
    v_mfma_f32_16x16x32_bf16 v[12:15], v[188:191], v[128:131], v[12:15]
    v_mfma_f32_16x16x32_bf16 v[112:115], v[160:163], v[148:151], v[112:115]
    s_add_u32 s35, s33, 1081344
    s_waitcnt vmcnt(6)
    ds_read_b64_tr_b16 v[176:177], v226 offset:4096
    ds_read_b64_tr_b16 v[180:181], v227 offset:4096
    ds_read_b64_tr_b16 v[184:185], v253 offset:4096
    ds_read_b64_tr_b16 v[188:189], v254 offset:4096
    v_mfma_f32_16x16x32_bf16 v[116:119], v[164:167], v[148:151], v[116:119]
    v_mfma_f32_16x16x32_bf16 v[120:123], v[168:171], v[148:151], v[120:123]
    v_mfma_f32_16x16x32_bf16 v[124:127], v[172:175], v[148:151], v[124:127]
    ds_read_b128 v[148:151], v228 offset:704
    v_mfma_f32_16x16x32_bf16 v[96:99], v[160:163], v[144:147], v[96:99]
    v_mfma_f32_16x16x32_bf16 v[100:103], v[164:167], v[144:147], v[100:103]
    v_mfma_f32_16x16x32_bf16 v[104:107], v[168:171], v[144:147], v[104:107]
    s_add_u32 m0, s41, 4096
    v_mfma_f32_16x16x32_bf16 v[108:111], v[172:175], v[144:147], v[108:111]
    ds_read_b128 v[144:147], v228 offset:576
    s_waitcnt lgkmcnt(2)
    buffer_load_dwordx4 v224, s[16:19], s35 offen lds
    v_mfma_f32_16x16x32_bf16 v[80:83], v[160:163], v[140:143], v[80:83]
    s_add_u32 m0, s41, 5120
    v_mfma_f32_16x16x32_bf16 v[84:87], v[164:167], v[140:143], v[84:87]
    buffer_load_dwordx4 v225, s[16:19], s35 offen lds
    v_mfma_f32_16x16x32_bf16 v[88:91], v[168:171], v[140:143], v[88:91]
    v_mfma_f32_16x16x32_bf16 v[92:95], v[172:175], v[140:143], v[92:95]
    v_mfma_f32_16x16x32_bf16 v[64:67], v[160:163], v[136:139], v[64:67]
    v_mfma_f32_16x16x32_bf16 v[68:71], v[164:167], v[136:139], v[68:71]
    v_mfma_f32_16x16x32_bf16 v[72:75], v[168:171], v[136:139], v[72:75]
    v_mfma_f32_16x16x32_bf16 v[76:79], v[172:175], v[136:139], v[76:79]
    v_mfma_f32_16x16x32_bf16 v[48:51], v[160:163], v[132:135], v[48:51]
    s_waitcnt vmcnt(6)
    ds_read_b64_tr_b16 v[178:179], v226 offset:6144
    ds_read_b64_tr_b16 v[182:183], v227 offset:6144
    ds_read_b64_tr_b16 v[186:187], v253 offset:6144
    ds_read_b64_tr_b16 v[190:191], v254 offset:6144
    v_mfma_f32_16x16x32_bf16 v[52:55], v[164:167], v[132:135], v[52:55]
    v_mfma_f32_16x16x32_bf16 v[56:59], v[168:171], v[132:135], v[56:59]
    v_mfma_f32_16x16x32_bf16 v[60:63], v[172:175], v[132:135], v[60:63]
    v_mfma_f32_16x16x32_bf16 v[32:35], v[160:163], v[128:131], v[32:35]
    v_mfma_f32_16x16x32_bf16 v[36:39], v[164:167], v[128:131], v[36:39]
    v_mfma_f32_16x16x32_bf16 v[40:43], v[168:171], v[128:131], v[40:43]
    s_add_u32 m0, s41, 6144
    v_mfma_f32_16x16x32_bf16 v[44:47], v[172:175], v[128:131], v[44:47]
    s_waitcnt lgkmcnt(0)
    buffer_load_dwordx4 v249, s[16:19], s35 offen lds
    v_mfma_f32_16x16x32_bf16 v[16:19], v[160:163], v[156:159], v[16:19]
    s_add_u32 m0, s41, 7168
    v_mfma_f32_16x16x32_bf16 v[20:23], v[164:167], v[156:159], v[20:23]
    buffer_load_dwordx4 v252, s[16:19], s35 offen lds
    v_mfma_f32_16x16x32_bf16 v[24:27], v[168:171], v[156:159], v[24:27]
    v_mfma_f32_16x16x32_bf16 v[28:31], v[172:175], v[156:159], v[28:31]
    v_mfma_f32_16x16x32_bf16 v[0:3], v[160:163], v[152:155], v[0:3]
    v_mfma_f32_16x16x32_bf16 v[4:7], v[164:167], v[152:155], v[4:7]
    v_mfma_f32_16x16x32_bf16 v[8:11], v[168:171], v[152:155], v[8:11]
    v_mfma_f32_16x16x32_bf16 v[12:15], v[172:175], v[152:155], v[12:15]
    v_mfma_f32_16x16x32_bf16 v[112:115], v[176:179], v[140:143], v[112:115]
    s_add_u32 s35, s33, 65536
    s_cmp_eq_u32 s34, 3
    s_cselect_b32 s18, 0, s18
    s_waitcnt vmcnt(6)
    ds_read_b64_tr_b16 v[160:161], v226 offset:0
    ds_read_b64_tr_b16 v[164:165], v227 offset:0
    ds_read_b64_tr_b16 v[168:169], v253 offset:0
    ds_read_b64_tr_b16 v[172:173], v254 offset:0
    v_mfma_f32_16x16x32_bf16 v[116:119], v[180:183], v[140:143], v[116:119]
    v_mfma_f32_16x16x32_bf16 v[120:123], v[184:187], v[140:143], v[120:123]
    s_cmp_eq_u32 s45, 0
    s_cbranch_scc1 L_hsig
    s_mov_b64 exec, 1
    ds_add_u32 v248, v237
    s_mov_b64 exec, -1
L_hsig:
    v_mfma_f32_16x16x32_bf16 v[124:127], v[188:191], v[140:143], v[124:127]
    ds_read_b128 v[140:143], v228 offset:448
    v_mfma_f32_16x16x32_bf16 v[96:99], v[176:179], v[136:139], v[96:99]
    v_mfma_f32_16x16x32_bf16 v[100:103], v[180:183], v[136:139], v[100:103]
    v_mfma_f32_16x16x32_bf16 v[104:107], v[184:187], v[136:139], v[104:107]
    s_add_u32 m0, s41, 0
    v_mfma_f32_16x16x32_bf16 v[108:111], v[188:191], v[136:139], v[108:111]
    ds_read_b128 v[136:139], v228 offset:320
    s_waitcnt lgkmcnt(2)
    buffer_load_dwordx4 v224, s[16:19], s35 offen lds
    v_mfma_f32_16x16x32_bf16 v[80:83], v[176:179], v[132:135], v[80:83]
    s_add_u32 m0, s41, 1024
    v_mfma_f32_16x16x32_bf16 v[84:87], v[180:183], v[132:135], v[84:87]
    buffer_load_dwordx4 v225, s[16:19], s35 offen lds
    v_mfma_f32_16x16x32_bf16 v[88:91], v[184:187], v[132:135], v[88:91]
    v_mfma_f32_16x16x32_bf16 v[92:95], v[188:191], v[132:135], v[92:95]
    v_mfma_f32_16x16x32_bf16 v[64:67], v[176:179], v[128:131], v[64:67]
    v_mfma_f32_16x16x32_bf16 v[68:71], v[180:183], v[128:131], v[68:71]
    v_mfma_f32_16x16x32_bf16 v[72:75], v[184:187], v[128:131], v[72:75]
    v_mfma_f32_16x16x32_bf16 v[76:79], v[188:191], v[128:131], v[76:79]
    v_mfma_f32_16x16x32_bf16 v[48:51], v[176:179], v[156:159], v[48:51]
    s_waitcnt vmcnt(6)
    ds_read_b64_tr_b16 v[162:163], v226 offset:2048
    ds_read_b64_tr_b16 v[166:167], v227 offset:2048
    ds_read_b64_tr_b16 v[170:171], v253 offset:2048
    ds_read_b64_tr_b16 v[174:175], v254 offset:2048
    v_mfma_f32_16x16x32_bf16 v[52:55], v[180:183], v[156:159], v[52:55]
    v_mfma_f32_16x16x32_bf16 v[56:59], v[184:187], v[156:159], v[56:59]
    v_mfma_f32_16x16x32_bf16 v[60:63], v[188:191], v[156:159], v[60:63]
    v_mfma_f32_16x16x32_bf16 v[32:35], v[176:179], v[152:155], v[32:35]
    v_mfma_f32_16x16x32_bf16 v[36:39], v[180:183], v[152:155], v[36:39]
    v_mfma_f32_16x16x32_bf16 v[40:43], v[184:187], v[152:155], v[40:43]
    s_add_u32 m0, s41, 2048
    v_mfma_f32_16x16x32_bf16 v[44:47], v[188:191], v[152:155], v[44:47]
    s_waitcnt lgkmcnt(0)
    buffer_load_dwordx4 v249, s[16:19], s35 offen lds
    v_mfma_f32_16x16x32_bf16 v[16:19], v[176:179], v[148:151], v[16:19]
    s_add_u32 m0, s41, 3072
    v_mfma_f32_16x16x32_bf16 v[20:23], v[180:183], v[148:151], v[20:23]
    buffer_load_dwordx4 v252, s[16:19], s35 offen lds
    v_mfma_f32_16x16x32_bf16 v[24:27], v[184:187], v[148:151], v[24:27]
    v_mfma_f32_16x16x32_bf16 v[28:31], v[188:191], v[148:151], v[28:31]
    v_mfma_f32_16x16x32_bf16 v[0:3], v[176:179], v[144:147], v[0:3]
    v_mfma_f32_16x16x32_bf16 v[4:7], v[180:183], v[144:147], v[4:7]
    v_mfma_f32_16x16x32_bf16 v[8:11], v[184:187], v[144:147], v[8:11]
    v_mfma_f32_16x16x32_bf16 v[12:15], v[188:191], v[144:147], v[12:15]
    v_mfma_f32_16x16x32_bf16 v[112:115], v[160:163], v[132:135], v[112:115]
    s_add_u32 s35, s33, 327680
    s_waitcnt vmcnt(6)
    ds_read_b64_tr_b16 v[176:177], v226 offset:4096
    ds_read_b64_tr_b16 v[180:181], v227 offset:4096
    ds_read_b64_tr_b16 v[184:185], v253 offset:4096
    ds_read_b64_tr_b16 v[188:189], v254 offset:4096
    v_mfma_f32_16x16x32_bf16 v[116:119], v[164:167], v[132:135], v[116:119]
    v_mfma_f32_16x16x32_bf16 v[120:123], v[168:171], v[132:135], v[120:123]
    v_mfma_f32_16x16x32_bf16 v[124:127], v[172:175], v[132:135], v[124:127]
    ds_read_b128 v[132:135], v228 offset:192
    v_mfma_f32_16x16x32_bf16 v[96:99], v[160:163], v[128:131], v[96:99]
    v_mfma_f32_16x16x32_bf16 v[100:103], v[164:167], v[128:131], v[100:103]
    v_mfma_f32_16x16x32_bf16 v[104:107], v[168:171], v[128:131], v[104:107]
    s_add_u32 m0, s41, 4096
    v_mfma_f32_16x16x32_bf16 v[108:111], v[172:175], v[128:131], v[108:111]
    ds_read_b128 v[128:131], v228 offset:64
    s_waitcnt lgkmcnt(2)
    buffer_load_dwordx4 v224, s[16:19], s35 offen lds
    v_mfma_f32_16x16x32_bf16 v[80:83], v[160:163], v[156:159], v[80:83]
    s_add_u32 m0, s41, 5120
    v_mfma_f32_16x16x32_bf16 v[84:87], v[164:167], v[156:159], v[84:87]
    buffer_load_dwordx4 v225, s[16:19], s35 offen lds
    v_mfma_f32_16x16x32_bf16 v[88:91], v[168:171], v[156:159], v[88:91]
    ds_read_b32 v236, v235
    v_mfma_f32_16x16x32_bf16 v[92:95], v[172:175], v[156:159], v[92:95]
    v_mfma_f32_16x16x32_bf16 v[64:67], v[160:163], v[152:155], v[64:67]
    v_mfma_f32_16x16x32_bf16 v[68:71], v[164:167], v[152:155], v[68:71]
    v_mfma_f32_16x16x32_bf16 v[72:75], v[168:171], v[152:155], v[72:75]
    v_mfma_f32_16x16x32_bf16 v[76:79], v[172:175], v[152:155], v[76:79]
    v_mfma_f32_16x16x32_bf16 v[48:51], v[160:163], v[148:151], v[48:51]
    s_waitcnt vmcnt(6)
    ds_read_b64_tr_b16 v[178:179], v226 offset:6144
    ds_read_b64_tr_b16 v[182:183], v227 offset:6144
    ds_read_b64_tr_b16 v[186:187], v253 offset:6144
    ds_read_b64_tr_b16 v[190:191], v254 offset:6144
    v_mfma_f32_16x16x32_bf16 v[52:55], v[164:167], v[148:151], v[52:55]
    v_mfma_f32_16x16x32_bf16 v[56:59], v[168:171], v[148:151], v[56:59]
    v_mfma_f32_16x16x32_bf16 v[60:63], v[172:175], v[148:151], v[60:63]
    v_mfma_f32_16x16x32_bf16 v[32:35], v[160:163], v[144:147], v[32:35]
    v_mfma_f32_16x16x32_bf16 v[36:39], v[164:167], v[144:147], v[36:39]
    v_mfma_f32_16x16x32_bf16 v[40:43], v[168:171], v[144:147], v[40:43]
    s_add_u32 m0, s41, 6144
    v_mfma_f32_16x16x32_bf16 v[44:47], v[172:175], v[144:147], v[44:47]
    s_waitcnt lgkmcnt(0)
    buffer_load_dwordx4 v249, s[16:19], s35 offen lds
    v_mfma_f32_16x16x32_bf16 v[16:19], v[160:163], v[140:143], v[16:19]
    s_add_u32 m0, s41, 7168
    v_mfma_f32_16x16x32_bf16 v[20:23], v[164:167], v[140:143], v[20:23]
    buffer_load_dwordx4 v252, s[16:19], s35 offen lds
    v_mfma_f32_16x16x32_bf16 v[24:27], v[168:171], v[140:143], v[24:27]
    v_mfma_f32_16x16x32_bf16 v[28:31], v[172:175], v[140:143], v[28:31]
    v_mfma_f32_16x16x32_bf16 v[0:3], v[160:163], v[136:139], v[0:3]
    v_mfma_f32_16x16x32_bf16 v[4:7], v[164:167], v[136:139], v[4:7]
    v_mfma_f32_16x16x32_bf16 v[8:11], v[168:171], v[136:139], v[8:11]
    v_mfma_f32_16x16x32_bf16 v[12:15], v[172:175], v[136:139], v[12:15]
    s_cmp_eq_u32 s34, 3
    s_cbranch_scc1 L_last
    v_readfirstlane_b32 s36, v236
    v_add_u32 v228, 17952, v228
    s_cmp_eq_u32 s36, 4
    s_cbranch_scc1 L_pok
L_pspin:
    ds_read_b32 v236, v235
    s_waitcnt lgkmcnt(0)
    v_readfirstlane_b32 s36, v236
    s_cmp_eq_u32 s36, 4
    s_cbranch_scc0 L_pspin
L_pok:
    v_add_u32 v235, 4, v235
    v_mfma_f32_16x16x32_bf16 v[112:115], v[176:179], v[156:159], v[112:115]
    s_add_u32 s35, s33, 589824
    s_waitcnt vmcnt(6)
    ds_read_b64_tr_b16 v[160:161], v226 offset:0
    ds_read_b64_tr_b16 v[164:165], v227 offset:0
    ds_read_b64_tr_b16 v[168:169], v253 offset:0
    ds_read_b64_tr_b16 v[172:173], v254 offset:0
    v_mfma_f32_16x16x32_bf16 v[116:119], v[180:183], v[156:159], v[116:119]
    v_mfma_f32_16x16x32_bf16 v[120:123], v[184:187], v[156:159], v[120:123]
    v_mfma_f32_16x16x32_bf16 v[124:127], v[188:191], v[156:159], v[124:127]
    ds_read_b128 v[156:159], v228 offset:1952
    v_mfma_f32_16x16x32_bf16 v[96:99], v[176:179], v[152:155], v[96:99]
    v_mfma_f32_16x16x32_bf16 v[100:103], v[180:183], v[152:155], v[100:103]
    v_mfma_f32_16x16x32_bf16 v[104:107], v[184:187], v[152:155], v[104:107]
    s_add_u32 m0, s41, 0
    v_mfma_f32_16x16x32_bf16 v[108:111], v[188:191], v[152:155], v[108:111]
    ds_read_b128 v[152:155], v228 offset:1824
    s_waitcnt lgkmcnt(2)
    buffer_load_dwordx4 v224, s[16:19], s35 offen lds
    v_mfma_f32_16x16x32_bf16 v[80:83], v[176:179], v[148:151], v[80:83]
    s_add_u32 m0, s41, 1024
    v_mfma_f32_16x16x32_bf16 v[84:87], v[180:183], v[148:151], v[84:87]
    buffer_load_dwordx4 v225, s[16:19], s35 offen lds
    v_mfma_f32_16x16x32_bf16 v[88:91], v[184:187], v[148:151], v[88:91]
    v_mfma_f32_16x16x32_bf16 v[92:95], v[188:191], v[148:151], v[92:95]
    ds_read_b128 v[148:151], v228 offset:1696
    v_mfma_f32_16x16x32_bf16 v[64:67], v[176:179], v[144:147], v[64:67]
    v_mfma_f32_16x16x32_bf16 v[68:71], v[180:183], v[144:147], v[68:71]
    v_mfma_f32_16x16x32_bf16 v[72:75], v[184:187], v[144:147], v[72:75]
    v_mfma_f32_16x16x32_bf16 v[76:79], v[188:191], v[144:147], v[76:79]
    ds_read_b128 v[144:147], v228 offset:1568
    v_mfma_f32_16x16x32_bf16 v[48:51], v[176:179], v[140:143], v[48:51]
    s_waitcnt vmcnt(6)
    ds_read_b64_tr_b16 v[162:163], v226 offset:2048
    ds_read_b64_tr_b16 v[166:167], v227 offset:2048
    ds_read_b64_tr_b16 v[170:171], v253 offset:2048
    ds_read_b64_tr_b16 v[174:175], v254 offset:2048
    v_mfma_f32_16x16x32_bf16 v[52:55], v[180:183], v[140:143], v[52:55]
    v_mfma_f32_16x16x32_bf16 v[56:59], v[184:187], v[140:143], v[56:59]
    v_mfma_f32_16x16x32_bf16 v[60:63], v[188:191], v[140:143], v[60:63]
    ds_read_b128 v[140:143], v228 offset:1440
    v_mfma_f32_16x16x32_bf16 v[32:35], v[176:179], v[136:139], v[32:35]
    v_mfma_f32_16x16x32_bf16 v[36:39], v[180:183], v[136:139], v[36:39]
    v_mfma_f32_16x16x32_bf16 v[40:43], v[184:187], v[136:139], v[40:43]
    s_add_u32 m0, s41, 2048
    v_mfma_f32_16x16x32_bf16 v[44:47], v[188:191], v[136:139], v[44:47]
    ds_read_b128 v[136:139], v228 offset:1312
    s_waitcnt lgkmcnt(2)
    buffer_load_dwordx4 v249, s[16:19], s35 offen lds
    v_mfma_f32_16x16x32_bf16 v[16:19], v[176:179], v[132:135], v[16:19]
    s_add_u32 m0, s41, 3072
    v_mfma_f32_16x16x32_bf16 v[20:23], v[180:183], v[132:135], v[20:23]
    buffer_load_dwordx4 v252, s[16:19], s35 offen lds
    v_mfma_f32_16x16x32_bf16 v[24:27], v[184:187], v[132:135], v[24:27]
    v_mfma_f32_16x16x32_bf16 v[28:31], v[188:191], v[132:135], v[28:31]
    ds_read_b128 v[132:135], v228 offset:1184
    v_mfma_f32_16x16x32_bf16 v[0:3], v[176:179], v[128:131], v[0:3]
    v_mfma_f32_16x16x32_bf16 v[4:7], v[180:183], v[128:131], v[4:7]
    v_mfma_f32_16x16x32_bf16 v[8:11], v[184:187], v[128:131], v[8:11]
    v_mfma_f32_16x16x32_bf16 v[12:15], v[188:191], v[128:131], v[12:15]
    ds_read_b128 v[128:131], v228 offset:1056
    s_add_u32 s33, s33, 65536
    s_add_u32 s34, s34, 1
    s_add_u32 s48, s48, 17952
    s_add_u32 s49, s49, 128
    v_add_u32 v248, 4, v248
    s_cmp_gt_u32 s34, s57
    s_cselect_b32 s45, 0, s45
    s_cselect_b32 s90, 0, s90
    s_mul_i32 s36, s57, 1
    s_add_u32 s36, s36, 1
    s_cmp_lg_u32 s36, s34
    s_cbranch_scc1 L_nsp
    s_setprio 1
    s_cmp_lg_u32 s57, 0
    s_cbranch_scc1 L_nsp
    s_setprio 2
L_nsp:
    s_branch L_loop
L_last:
    s_cbranch_vccnz L_ls1
    v_mfma_f32_16x16x32_bf16 v[120:123], v[184:187], v[156:159], v[120:123]
    v_mfma_f32_16x16x32_bf16 v[124:127], v[188:191], v[156:159], v[124:127]
    v_mfma_f32_16x16x32_bf16 v[112:115], v[176:179], v[156:159], v[112:115]
    v_mfma_f32_16x16x32_bf16 v[116:119], v[180:183], v[156:159], v[116:119]
    v_mfma_f32_16x16x32_bf16 v[104:107], v[184:187], v[152:155], v[104:107]
    v_cvt_pk_f16_f32 v196, v120, v121
    v_cvt_pk_f16_f32 v197, v122, v123
    v_mfma_f32_16x16x32_bf16 v[108:111], v[188:191], v[152:155], v[108:111]
    v_cvt_pk_f16_f32 v198, v124, v125
    v_cvt_pk_f16_f32 v199, v126, v127
    v_mfma_f32_16x16x32_bf16 v[96:99], v[176:179], v[152:155], v[96:99]
    s_waitcnt vmcnt(0)
    ds_write_b128 v230, v[196:199] offset:7168
    v_mfma_f32_16x16x32_bf16 v[100:103], v[180:183], v[152:155], v[100:103]
    v_mfma_f32_16x16x32_bf16 v[88:91], v[184:187], v[148:151], v[88:91]
    v_cvt_pk_f16_f32 v192, v104, v105
    v_cvt_pk_f16_f32 v193, v106, v107
    v_mfma_f32_16x16x32_bf16 v[92:95], v[188:191], v[148:151], v[92:95]
    v_cvt_pk_f16_f32 v194, v108, v109
    v_cvt_pk_f16_f32 v195, v110, v111
    v_mfma_f32_16x16x32_bf16 v[80:83], v[176:179], v[148:151], v[80:83]
    ds_write_b128 v230, v[192:195] offset:6144
    v_mfma_f32_16x16x32_bf16 v[84:87], v[180:183], v[148:151], v[84:87]
    v_mfma_f32_16x16x32_bf16 v[72:75], v[184:187], v[144:147], v[72:75]
    v_cvt_pk_f16_f32 v196, v88, v89
    v_cvt_pk_f16_f32 v197, v90, v91
    v_mfma_f32_16x16x32_bf16 v[76:79], v[188:191], v[144:147], v[76:79]
    v_cvt_pk_f16_f32 v198, v92, v93
    v_cvt_pk_f16_f32 v199, v94, v95
    v_mfma_f32_16x16x32_bf16 v[64:67], v[176:179], v[144:147], v[64:67]
    ds_write_b128 v230, v[196:199] offset:5120
    v_mfma_f32_16x16x32_bf16 v[68:71], v[180:183], v[144:147], v[68:71]
    v_mfma_f32_16x16x32_bf16 v[56:59], v[184:187], v[140:143], v[56:59]
    v_cvt_pk_f16_f32 v192, v72, v73
    v_cvt_pk_f16_f32 v193, v74, v75
    v_mfma_f32_16x16x32_bf16 v[60:63], v[188:191], v[140:143], v[60:63]
    v_cvt_pk_f16_f32 v194, v76, v77
    v_cvt_pk_f16_f32 v195, v78, v79
    v_mfma_f32_16x16x32_bf16 v[48:51], v[176:179], v[140:143], v[48:51]
    ds_write_b128 v230, v[192:195] offset:4096
    v_mfma_f32_16x16x32_bf16 v[52:55], v[180:183], v[140:143], v[52:55]
    v_mfma_f32_16x16x32_bf16 v[40:43], v[184:187], v[136:139], v[40:43]
    v_cvt_pk_f16_f32 v196, v56, v57
    v_cvt_pk_f16_f32 v197, v58, v59
    v_mfma_f32_16x16x32_bf16 v[44:47], v[188:191], v[136:139], v[44:47]
    v_cvt_pk_f16_f32 v198, v60, v61
    v_cvt_pk_f16_f32 v199, v62, v63
    v_mfma_f32_16x16x32_bf16 v[32:35], v[176:179], v[136:139], v[32:35]
    ds_write_b128 v230, v[196:199] offset:3072
    v_mfma_f32_16x16x32_bf16 v[36:39], v[180:183], v[136:139], v[36:39]
    v_mfma_f32_16x16x32_bf16 v[24:27], v[184:187], v[132:135], v[24:27]
    v_cvt_pk_f16_f32 v192, v40, v41
    v_cvt_pk_f16_f32 v193, v42, v43
    v_mfma_f32_16x16x32_bf16 v[28:31], v[188:191], v[132:135], v[28:31]
    v_cvt_pk_f16_f32 v194, v44, v45
    v_cvt_pk_f16_f32 v195, v46, v47
    v_mfma_f32_16x16x32_bf16 v[16:19], v[176:179], v[132:135], v[16:19]
    ds_write_b128 v230, v[192:195] offset:2048
    v_mfma_f32_16x16x32_bf16 v[20:23], v[180:183], v[132:135], v[20:23]
    v_mfma_f32_16x16x32_bf16 v[8:11], v[184:187], v[128:131], v[8:11]
    v_cvt_pk_f16_f32 v196, v24, v25
    v_cvt_pk_f16_f32 v197, v26, v27
    v_mfma_f32_16x16x32_bf16 v[12:15], v[188:191], v[128:131], v[12:15]
    v_cvt_pk_f16_f32 v198, v28, v29
    v_cvt_pk_f16_f32 v199, v30, v31
    v_mfma_f32_16x16x32_bf16 v[0:3], v[176:179], v[128:131], v[0:3]
    ds_write_b128 v230, v[196:199] offset:1024
    v_mfma_f32_16x16x32_bf16 v[4:7], v[180:183], v[128:131], v[4:7]
    s_nop 7
    v_cvt_pk_f16_f32 v192, v8, v9
    v_cvt_pk_f16_f32 v193, v10, v11
    v_cvt_pk_f16_f32 v194, v12, v13
    v_cvt_pk_f16_f32 v195, v14, v15
    ds_write_b128 v230, v[192:195] offset:0
    s_mov_b64 exec, 1
    ds_write_b32 v242, v237
    s_mov_b64 exec, -1
    s_branch L_ls2
L_ls1:
    v_mfma_f32_16x16x32_bf16 v[112:115], v[176:179], v[156:159], v[112:115]
    v_mfma_f32_16x16x32_bf16 v[116:119], v[180:183], v[156:159], v[116:119]
    v_mfma_f32_16x16x32_bf16 v[120:123], v[184:187], v[156:159], v[120:123]
    v_mfma_f32_16x16x32_bf16 v[124:127], v[188:191], v[156:159], v[124:127]
    v_mfma_f32_16x16x32_bf16 v[96:99], v[176:179], v[152:155], v[96:99]
    v_cvt_pk_f16_f32 v196, v112, v113
    v_cvt_pk_f16_f32 v197, v114, v115
    v_mfma_f32_16x16x32_bf16 v[100:103], v[180:183], v[152:155], v[100:103]
    v_cvt_pk_f16_f32 v198, v116, v117
    v_cvt_pk_f16_f32 v199, v118, v119
    v_mfma_f32_16x16x32_bf16 v[104:107], v[184:187], v[152:155], v[104:107]
    s_waitcnt vmcnt(0)
    ds_write_b128 v230, v[196:199] offset:7168
    v_mfma_f32_16x16x32_bf16 v[108:111], v[188:191], v[152:155], v[108:111]
    v_mfma_f32_16x16x32_bf16 v[80:83], v[176:179], v[148:151], v[80:83]
    v_cvt_pk_f16_f32 v192, v96, v97
    v_cvt_pk_f16_f32 v193, v98, v99
    v_mfma_f32_16x16x32_bf16 v[84:87], v[180:183], v[148:151], v[84:87]
    v_cvt_pk_f16_f32 v194, v100, v101
    v_cvt_pk_f16_f32 v195, v102, v103
    v_mfma_f32_16x16x32_bf16 v[88:91], v[184:187], v[148:151], v[88:91]
    ds_write_b128 v230, v[192:195] offset:6144
    v_mfma_f32_16x16x32_bf16 v[92:95], v[188:191], v[148:151], v[92:95]
    v_mfma_f32_16x16x32_bf16 v[64:67], v[176:179], v[144:147], v[64:67]
    v_cvt_pk_f16_f32 v196, v80, v81
    v_cvt_pk_f16_f32 v197, v82, v83
    v_mfma_f32_16x16x32_bf16 v[68:71], v[180:183], v[144:147], v[68:71]
    v_cvt_pk_f16_f32 v198, v84, v85
    v_cvt_pk_f16_f32 v199, v86, v87
    v_mfma_f32_16x16x32_bf16 v[72:75], v[184:187], v[144:147], v[72:75]
    ds_write_b128 v230, v[196:199] offset:5120
    v_mfma_f32_16x16x32_bf16 v[76:79], v[188:191], v[144:147], v[76:79]
    v_mfma_f32_16x16x32_bf16 v[48:51], v[176:179], v[140:143], v[48:51]
    v_cvt_pk_f16_f32 v192, v64, v65
    v_cvt_pk_f16_f32 v193, v66, v67
    v_mfma_f32_16x16x32_bf16 v[52:55], v[180:183], v[140:143], v[52:55]
    v_cvt_pk_f16_f32 v194, v68, v69
    v_cvt_pk_f16_f32 v195, v70, v71
    v_mfma_f32_16x16x32_bf16 v[56:59], v[184:187], v[140:143], v[56:59]
    ds_write_b128 v230, v[192:195] offset:4096
    v_mfma_f32_16x16x32_bf16 v[60:63], v[188:191], v[140:143], v[60:63]
    v_mfma_f32_16x16x32_bf16 v[32:35], v[176:179], v[136:139], v[32:35]
    v_cvt_pk_f16_f32 v196, v48, v49
    v_cvt_pk_f16_f32 v197, v50, v51
    v_mfma_f32_16x16x32_bf16 v[36:39], v[180:183], v[136:139], v[36:39]
    v_cvt_pk_f16_f32 v198, v52, v53
    v_cvt_pk_f16_f32 v199, v54, v55
    v_mfma_f32_16x16x32_bf16 v[40:43], v[184:187], v[136:139], v[40:43]
    ds_write_b128 v230, v[196:199] offset:3072
    v_mfma_f32_16x16x32_bf16 v[44:47], v[188:191], v[136:139], v[44:47]
    v_mfma_f32_16x16x32_bf16 v[16:19], v[176:179], v[132:135], v[16:19]
    v_cvt_pk_f16_f32 v192, v32, v33
    v_cvt_pk_f16_f32 v193, v34, v35
    v_mfma_f32_16x16x32_bf16 v[20:23], v[180:183], v[132:135], v[20:23]
    v_cvt_pk_f16_f32 v194, v36, v37
    v_cvt_pk_f16_f32 v195, v38, v39
    v_mfma_f32_16x16x32_bf16 v[24:27], v[184:187], v[132:135], v[24:27]
    ds_write_b128 v230, v[192:195] offset:2048
    v_mfma_f32_16x16x32_bf16 v[28:31], v[188:191], v[132:135], v[28:31]
    v_mfma_f32_16x16x32_bf16 v[0:3], v[176:179], v[128:131], v[0:3]
    v_cvt_pk_f16_f32 v196, v16, v17
    v_cvt_pk_f16_f32 v197, v18, v19
    v_mfma_f32_16x16x32_bf16 v[4:7], v[180:183], v[128:131], v[4:7]
    v_cvt_pk_f16_f32 v198, v20, v21
    v_cvt_pk_f16_f32 v199, v22, v23
    v_mfma_f32_16x16x32_bf16 v[8:11], v[184:187], v[128:131], v[8:11]
    ds_write_b128 v230, v[196:199] offset:1024
    v_mfma_f32_16x16x32_bf16 v[12:15], v[188:191], v[128:131], v[12:15]
    s_nop 7
    v_cvt_pk_f16_f32 v192, v0, v1
    v_cvt_pk_f16_f32 v193, v2, v3
    v_cvt_pk_f16_f32 v194, v4, v5
    v_cvt_pk_f16_f32 v195, v6, v7
    ds_write_b128 v230, v[192:195] offset:0
    s_mov_b64 exec, 1
    ds_write_b32 v242, v237
    s_mov_b64 exec, -1
L_ls2:
    s_and_b32 s37, s32, 1
    s_lshl_b32 s36, s37, 14
    s_sub_u32 s36, 8192, s36
    v_add_u32 v224, s36, v230
    v_xor_b32 v242, 4, v242
    s_cmp_lg_u32 s57, 0
    s_cbranch_scc1 L_low
    s_setprio 0
    s_add_u32 m0, s56, 0
    s_mov_b32 s35, 0
    buffer_load_dwordx4 v231, s[20:23], s35 offen offset:0 lds
    s_add_u32 m0, s56, 1024
    s_mov_b32 s35, 8192
    buffer_load_dwordx4 v231, s[20:23], s35 offen offset:0 lds
    s_add_u32 m0, s56, 1984
    s_mov_b32 s35, 0
    buffer_load_dwordx4 v231, s[20:23], s35 offen offset:64 lds
    s_add_u32 m0, s56, 3008
    s_mov_b32 s35, 8192
    buffer_load_dwordx4 v231, s[20:23], s35 offen offset:64 lds
    s_add_u32 m0, s56, 4096
    s_mov_b32 s35, 16384
    buffer_load_dwordx4 v231, s[20:23], s35 offen offset:0 lds
    s_add_u32 m0, s56, 5120
    s_mov_b32 s35, 24576
    buffer_load_dwordx4 v231, s[20:23], s35 offen offset:0 lds
L_xph:
    ds_read_b32 v236, v242 offset:0
    s_waitcnt lgkmcnt(0)
    v_readfirstlane_b32 s36, v236
    s_cmp_eq_u32 s36, 1
    s_cbranch_scc0 L_xph
    ds_read_b128 v[252:255], v224 offset:7168
    ds_read_b128 v[248:251], v224 offset:6144
    s_waitcnt lgkmcnt(1)
    s_cbranch_vccnz L_ro0
    v_mul_f32 v128, s42, v112
    v_mul_f32 v129, s42, v113
    v_mul_f32 v130, s42, v114
    v_mul_f32 v131, s42, v115
    v_fma_mix_f32 v132, s43, v252, 0 op_sel:[0,0,0] op_sel_hi:[0,1,0]
    v_fma_mix_f32 v133, s43, v252, 0 op_sel:[0,1,0] op_sel_hi:[0,1,0]
    v_fma_mix_f32 v134, s43, v253, 0 op_sel:[0,0,0] op_sel_hi:[0,1,0]
    v_fma_mix_f32 v135, s43, v253, 0 op_sel:[0,1,0] op_sel_hi:[0,1,0]
    s_branch L_re0
L_ro0:
    v_fma_mix_f32 v128, s42, v252, 0 op_sel:[0,0,0] op_sel_hi:[0,1,0]
    v_fma_mix_f32 v129, s42, v252, 0 op_sel:[0,1,0] op_sel_hi:[0,1,0]
    v_fma_mix_f32 v130, s42, v253, 0 op_sel:[0,0,0] op_sel_hi:[0,1,0]
    v_fma_mix_f32 v131, s42, v253, 0 op_sel:[0,1,0] op_sel_hi:[0,1,0]
    v_mul_f32 v132, s43, v120
    v_mul_f32 v133, s43, v121
    v_mul_f32 v134, s43, v122
    v_mul_f32 v135, s43, v123
L_re0:
    v_min_f32 v128, s44, v128
    v_min_f32 v129, s44, v129
    v_min_f32 v130, s44, v130
    v_min_f32 v131, s44, v131
    v_exp_f32 v132, v132
    v_exp_f32 v133, v133
    v_exp_f32 v134, v134
    v_exp_f32 v135, v135
    v_exp_f32 v128, v128
    v_exp_f32 v129, v129
    v_exp_f32 v130, v130
    v_exp_f32 v131, v131
    s_nop 0
    v_add_f32 v136, 1.0, v128
    v_add_f32 v137, 1.0, v129
    v_add_f32 v138, 1.0, v130
    v_add_f32 v139, 1.0, v131
    v_fma_f32 v136, v136, v132, v136
    v_fma_f32 v137, v137, v133, v137
    v_fma_f32 v138, v138, v134, v138
    v_fma_f32 v139, v139, v135, v139
    v_rcp_f32 v136, v136
    v_rcp_f32 v137, v137
    v_rcp_f32 v138, v138
    v_rcp_f32 v139, v139
    v_sub_f32 v128, 1.0, v128
    v_sub_f32 v129, 1.0, v129
    v_sub_f32 v130, 1.0, v130
    v_sub_f32 v131, 1.0, v131
    v_mul_f32 v140, v128, v136
    v_mul_f32 v141, v129, v137
    v_mul_f32 v142, v130, v138
    v_mul_f32 v143, v131, v139
    v_cvt_pk_bf16_f32 v144, v140, v141
    v_cvt_pk_bf16_f32 v145, v142, v143
    s_cbranch_vccnz L_ro1
    v_mul_f32 v128, s42, v116
    v_mul_f32 v129, s42, v117
    v_mul_f32 v130, s42, v118
    v_mul_f32 v131, s42, v119
    v_fma_mix_f32 v132, s43, v254, 0 op_sel:[0,0,0] op_sel_hi:[0,1,0]
    v_fma_mix_f32 v133, s43, v254, 0 op_sel:[0,1,0] op_sel_hi:[0,1,0]
    v_fma_mix_f32 v134, s43, v255, 0 op_sel:[0,0,0] op_sel_hi:[0,1,0]
    v_fma_mix_f32 v135, s43, v255, 0 op_sel:[0,1,0] op_sel_hi:[0,1,0]
    s_branch L_re1
L_ro1:
    v_fma_mix_f32 v128, s42, v254, 0 op_sel:[0,0,0] op_sel_hi:[0,1,0]
    v_fma_mix_f32 v129, s42, v254, 0 op_sel:[0,1,0] op_sel_hi:[0,1,0]
    v_fma_mix_f32 v130, s42, v255, 0 op_sel:[0,0,0] op_sel_hi:[0,1,0]
    v_fma_mix_f32 v131, s42, v255, 0 op_sel:[0,1,0] op_sel_hi:[0,1,0]
    v_mul_f32 v132, s43, v124
    v_mul_f32 v133, s43, v125
    v_mul_f32 v134, s43, v126
    v_mul_f32 v135, s43, v127
L_re1:
    v_min_f32 v128, s44, v128
    v_min_f32 v129, s44, v129
    v_min_f32 v130, s44, v130
    v_min_f32 v131, s44, v131
    v_exp_f32 v132, v132
    v_exp_f32 v133, v133
    v_exp_f32 v134, v134
    v_exp_f32 v135, v135
    v_exp_f32 v128, v128
    v_exp_f32 v129, v129
    v_exp_f32 v130, v130
    v_exp_f32 v131, v131
    s_nop 0
    v_add_f32 v136, 1.0, v128
    v_add_f32 v137, 1.0, v129
    v_add_f32 v138, 1.0, v130
    v_add_f32 v139, 1.0, v131
    v_fma_f32 v136, v136, v132, v136
    v_fma_f32 v137, v137, v133, v137
    v_fma_f32 v138, v138, v134, v138
    v_fma_f32 v139, v139, v135, v139
    v_rcp_f32 v136, v136
    v_rcp_f32 v137, v137
    v_rcp_f32 v138, v138
    v_rcp_f32 v139, v139
    v_sub_f32 v128, 1.0, v128
    v_sub_f32 v129, 1.0, v129
    v_sub_f32 v130, 1.0, v130
    v_sub_f32 v131, 1.0, v131
    v_mul_f32 v140, v128, v136
    v_mul_f32 v141, v129, v137
    v_mul_f32 v142, v130, v138
    v_mul_f32 v143, v131, v139
    v_cvt_pk_bf16_f32 v146, v140, v141
    v_cvt_pk_bf16_f32 v147, v142, v143
    ds_write_b128 v224, v[144:147] offset:7168
    s_waitcnt vmcnt(5)
    ds_read_b64_tr_b16 v[160:161], v232 offset:0
    ds_read_b64_tr_b16 v[164:165], v232 offset:8
    s_waitcnt vmcnt(4)
    ds_read_b64_tr_b16 v[162:163], v232 offset:1024
    ds_read_b64_tr_b16 v[166:167], v232 offset:1032
    ds_read_b128 v[252:255], v224 offset:5120
    s_waitcnt lgkmcnt(6)
    s_cbranch_vccnz L_ro2
    v_mul_f32 v128, s42, v96
    v_mul_f32 v129, s42, v97
    v_mul_f32 v130, s42, v98
    v_mul_f32 v131, s42, v99
    v_fma_mix_f32 v132, s43, v248, 0 op_sel:[0,0,0] op_sel_hi:[0,1,0]
    v_fma_mix_f32 v133, s43, v248, 0 op_sel:[0,1,0] op_sel_hi:[0,1,0]
    v_fma_mix_f32 v134, s43, v249, 0 op_sel:[0,0,0] op_sel_hi:[0,1,0]
    v_fma_mix_f32 v135, s43, v249, 0 op_sel:[0,1,0] op_sel_hi:[0,1,0]
    s_branch L_re2
L_ro2:
    v_fma_mix_f32 v128, s42, v248, 0 op_sel:[0,0,0] op_sel_hi:[0,1,0]
    v_fma_mix_f32 v129, s42, v248, 0 op_sel:[0,1,0] op_sel_hi:[0,1,0]
    v_fma_mix_f32 v130, s42, v249, 0 op_sel:[0,0,0] op_sel_hi:[0,1,0]
    v_fma_mix_f32 v131, s42, v249, 0 op_sel:[0,1,0] op_sel_hi:[0,1,0]
    v_mul_f32 v132, s43, v104
    v_mul_f32 v133, s43, v105
    v_mul_f32 v134, s43, v106
    v_mul_f32 v135, s43, v107
L_re2:
    v_min_f32 v128, s44, v128
    v_min_f32 v129, s44, v129
    v_min_f32 v130, s44, v130
    v_min_f32 v131, s44, v131
    v_exp_f32 v132, v132
    v_exp_f32 v133, v133
    v_exp_f32 v134, v134
    v_exp_f32 v135, v135
    v_exp_f32 v128, v128
    v_exp_f32 v129, v129
    v_exp_f32 v130, v130
    v_exp_f32 v131, v131
    s_nop 0
    v_add_f32 v136, 1.0, v128
    v_add_f32 v137, 1.0, v129
    v_add_f32 v138, 1.0, v130
    v_add_f32 v139, 1.0, v131
    v_fma_f32 v136, v136, v132, v136
    v_fma_f32 v137, v137, v133, v137
    v_fma_f32 v138, v138, v134, v138
    v_fma_f32 v139, v139, v135, v139
    v_rcp_f32 v136, v136
    v_rcp_f32 v137, v137
    v_rcp_f32 v138, v138
    v_rcp_f32 v139, v139
    v_sub_f32 v128, 1.0, v128
    v_sub_f32 v129, 1.0, v129
    v_sub_f32 v130, 1.0, v130
    v_sub_f32 v131, 1.0, v131
    v_mul_f32 v140, v128, v136
    v_mul_f32 v141, v129, v137
    v_mul_f32 v142, v130, v138
    v_mul_f32 v143, v131, v139
    v_cvt_pk_bf16_f32 v148, v140, v141
    v_cvt_pk_bf16_f32 v149, v142, v143
    s_cbranch_vccnz L_ro3
    v_mul_f32 v128, s42, v100
    v_mul_f32 v129, s42, v101
    v_mul_f32 v130, s42, v102
    v_mul_f32 v131, s42, v103
    v_fma_mix_f32 v132, s43, v250, 0 op_sel:[0,0,0] op_sel_hi:[0,1,0]
    v_fma_mix_f32 v133, s43, v250, 0 op_sel:[0,1,0] op_sel_hi:[0,1,0]
    v_fma_mix_f32 v134, s43, v251, 0 op_sel:[0,0,0] op_sel_hi:[0,1,0]
    v_fma_mix_f32 v135, s43, v251, 0 op_sel:[0,1,0] op_sel_hi:[0,1,0]
    s_branch L_re3
L_ro3:
    v_fma_mix_f32 v128, s42, v250, 0 op_sel:[0,0,0] op_sel_hi:[0,1,0]
    v_fma_mix_f32 v129, s42, v250, 0 op_sel:[0,1,0] op_sel_hi:[0,1,0]
    v_fma_mix_f32 v130, s42, v251, 0 op_sel:[0,0,0] op_sel_hi:[0,1,0]
    v_fma_mix_f32 v131, s42, v251, 0 op_sel:[0,1,0] op_sel_hi:[0,1,0]
    v_mul_f32 v132, s43, v108
    v_mul_f32 v133, s43, v109
    v_mul_f32 v134, s43, v110
    v_mul_f32 v135, s43, v111
L_re3:
    v_min_f32 v128, s44, v128
    v_min_f32 v129, s44, v129
    v_min_f32 v130, s44, v130
    v_min_f32 v131, s44, v131
    v_exp_f32 v132, v132
    v_exp_f32 v133, v133
    v_exp_f32 v134, v134
    v_exp_f32 v135, v135
    v_exp_f32 v128, v128
    v_exp_f32 v129, v129
    v_exp_f32 v130, v130
    v_exp_f32 v131, v131
    s_nop 0
    v_add_f32 v136, 1.0, v128
    v_add_f32 v137, 1.0, v129
    v_add_f32 v138, 1.0, v130
    v_add_f32 v139, 1.0, v131
    v_fma_f32 v136, v136, v132, v136
    v_fma_f32 v137, v137, v133, v137
    v_fma_f32 v138, v138, v134, v138
    v_fma_f32 v139, v139, v135, v139
    v_rcp_f32 v136, v136
    v_rcp_f32 v137, v137
    v_rcp_f32 v138, v138
    v_rcp_f32 v139, v139
    v_sub_f32 v128, 1.0, v128
    v_sub_f32 v129, 1.0, v129
    v_sub_f32 v130, 1.0, v130
    v_sub_f32 v131, 1.0, v131
    v_mul_f32 v140, v128, v136
    v_mul_f32 v141, v129, v137
    v_mul_f32 v142, v130, v138
    v_mul_f32 v143, v131, v139
    v_cvt_pk_bf16_f32 v150, v140, v141
    v_cvt_pk_bf16_f32 v151, v142, v143
    ds_write_b128 v224, v[148:151] offset:6144
    s_waitcnt lgkmcnt(2)
    s_sub_u32 m0, s56, 64
    s_mov_b32 s35, 16384
    buffer_load_dwordx4 v231, s[20:23], s35 offen offset:64 lds
    s_add_u32 m0, s56, 960
    s_mov_b32 s35, 24576
    buffer_load_dwordx4 v231, s[20:23], s35 offen offset:64 lds
    s_waitcnt vmcnt(5)
    ds_read_b64_tr_b16 v[168:169], v232 offset:2048
    ds_read_b64_tr_b16 v[172:173], v232 offset:2056
    s_waitcnt vmcnt(4)
    ds_read_b64_tr_b16 v[170:171], v232 offset:3072
    ds_read_b64_tr_b16 v[174:175], v232 offset:3080
    ds_read_b128 v[248:251], v224 offset:4096
    s_waitcnt lgkmcnt(6)
    s_cbranch_vccnz L_ro4
    v_mul_f32 v128, s42, v80
    v_mul_f32 v129, s42, v81
    v_mul_f32 v130, s42, v82
    v_mul_f32 v131, s42, v83
    v_fma_mix_f32 v132, s43, v252, 0 op_sel:[0,0,0] op_sel_hi:[0,1,0]
    v_fma_mix_f32 v133, s43, v252, 0 op_sel:[0,1,0] op_sel_hi:[0,1,0]
    v_fma_mix_f32 v134, s43, v253, 0 op_sel:[0,0,0] op_sel_hi:[0,1,0]
    v_fma_mix_f32 v135, s43, v253, 0 op_sel:[0,1,0] op_sel_hi:[0,1,0]
    s_branch L_re4
L_ro4:
    v_fma_mix_f32 v128, s42, v252, 0 op_sel:[0,0,0] op_sel_hi:[0,1,0]
    v_fma_mix_f32 v129, s42, v252, 0 op_sel:[0,1,0] op_sel_hi:[0,1,0]
    v_fma_mix_f32 v130, s42, v253, 0 op_sel:[0,0,0] op_sel_hi:[0,1,0]
    v_fma_mix_f32 v131, s42, v253, 0 op_sel:[0,1,0] op_sel_hi:[0,1,0]
    v_mul_f32 v132, s43, v88
    v_mul_f32 v133, s43, v89
    v_mul_f32 v134, s43, v90
    v_mul_f32 v135, s43, v91
L_re4:
    v_min_f32 v128, s44, v128
    v_min_f32 v129, s44, v129
    v_min_f32 v130, s44, v130
    v_min_f32 v131, s44, v131
    v_exp_f32 v132, v132
    v_exp_f32 v133, v133
    v_exp_f32 v134, v134
    v_exp_f32 v135, v135
    v_exp_f32 v128, v128
    v_exp_f32 v129, v129
    v_exp_f32 v130, v130
    v_exp_f32 v131, v131
    s_nop 0
    v_add_f32 v136, 1.0, v128
    v_add_f32 v137, 1.0, v129
    v_add_f32 v138, 1.0, v130
    v_add_f32 v139, 1.0, v131
    v_fma_f32 v136, v136, v132, v136
    v_fma_f32 v137, v137, v133, v137
    v_fma_f32 v138, v138, v134, v138
    v_fma_f32 v139, v139, v135, v139
    v_rcp_f32 v136, v136
    v_rcp_f32 v137, v137
    v_rcp_f32 v138, v138
    v_rcp_f32 v139, v139
    v_sub_f32 v128, 1.0, v128
    v_sub_f32 v129, 1.0, v129
    v_sub_f32 v130, 1.0, v130
    v_sub_f32 v131, 1.0, v131
    v_mul_f32 v140, v128, v136
    v_mul_f32 v141, v129, v137
    v_mul_f32 v142, v130, v138
    v_mul_f32 v143, v131, v139
    v_cvt_pk_bf16_f32 v152, v140, v141
    v_cvt_pk_bf16_f32 v153, v142, v143
    s_cbranch_vccnz L_ro5
    v_mul_f32 v128, s42, v84
    v_mul_f32 v129, s42, v85
    v_mul_f32 v130, s42, v86
    v_mul_f32 v131, s42, v87
    v_fma_mix_f32 v132, s43, v254, 0 op_sel:[0,0,0] op_sel_hi:[0,1,0]
    v_fma_mix_f32 v133, s43, v254, 0 op_sel:[0,1,0] op_sel_hi:[0,1,0]
    v_fma_mix_f32 v134, s43, v255, 0 op_sel:[0,0,0] op_sel_hi:[0,1,0]
    v_fma_mix_f32 v135, s43, v255, 0 op_sel:[0,1,0] op_sel_hi:[0,1,0]
    s_branch L_re5
L_ro5:
    v_fma_mix_f32 v128, s42, v254, 0 op_sel:[0,0,0] op_sel_hi:[0,1,0]
    v_fma_mix_f32 v129, s42, v254, 0 op_sel:[0,1,0] op_sel_hi:[0,1,0]
    v_fma_mix_f32 v130, s42, v255, 0 op_sel:[0,0,0] op_sel_hi:[0,1,0]
    v_fma_mix_f32 v131, s42, v255, 0 op_sel:[0,1,0] op_sel_hi:[0,1,0]
    v_mul_f32 v132, s43, v92
    v_mul_f32 v133, s43, v93
    v_mul_f32 v134, s43, v94
    v_mul_f32 v135, s43, v95
L_re5:
    v_min_f32 v128, s44, v128
    v_min_f32 v129, s44, v129
    v_min_f32 v130, s44, v130
    v_min_f32 v131, s44, v131
    v_exp_f32 v132, v132
    v_exp_f32 v133, v133
    v_exp_f32 v134, v134
    v_exp_f32 v135, v135
    v_exp_f32 v128, v128
    v_exp_f32 v129, v129
    v_exp_f32 v130, v130
    v_exp_f32 v131, v131
    s_nop 0
    v_add_f32 v136, 1.0, v128
    v_add_f32 v137, 1.0, v129
    v_add_f32 v138, 1.0, v130
    v_add_f32 v139, 1.0, v131
    v_fma_f32 v136, v136, v132, v136
    v_fma_f32 v137, v137, v133, v137
    v_fma_f32 v138, v138, v134, v138
    v_fma_f32 v139, v139, v135, v139
    v_rcp_f32 v136, v136
    v_rcp_f32 v137, v137
    v_rcp_f32 v138, v138
    v_rcp_f32 v139, v139
    v_sub_f32 v128, 1.0, v128
    v_sub_f32 v129, 1.0, v129
    v_sub_f32 v130, 1.0, v130
    v_sub_f32 v131, 1.0, v131
    v_mul_f32 v140, v128, v136
    v_mul_f32 v141, v129, v137
    v_mul_f32 v142, v130, v138
    v_mul_f32 v143, v131, v139
    v_cvt_pk_bf16_f32 v154, v140, v141
    v_cvt_pk_bf16_f32 v155, v142, v143
    ds_write_b128 v224, v[152:155] offset:5120
    s_waitcnt lgkmcnt(2)
    s_add_u32 m0, s56, 2048
    s_mov_b32 s35, 32768
    buffer_load_dwordx4 v231, s[20:23], s35 offen offset:0 lds
    s_add_u32 m0, s56, 3072
    s_mov_b32 s35, 40960
    buffer_load_dwordx4 v231, s[20:23], s35 offen offset:0 lds
    s_waitcnt vmcnt(5)
    ds_read_b64_tr_b16 v[176:177], v232 offset:4096
    ds_read_b64_tr_b16 v[180:181], v232 offset:4104
    s_waitcnt vmcnt(4)
    ds_read_b64_tr_b16 v[178:179], v232 offset:5120
    ds_read_b64_tr_b16 v[182:183], v232 offset:5128
    ds_read_b128 v[252:255], v224 offset:3072
    s_waitcnt lgkmcnt(6)
    s_cbranch_vccnz L_ro6
    v_mul_f32 v128, s42, v64
    v_mul_f32 v129, s42, v65
    v_mul_f32 v130, s42, v66
    v_mul_f32 v131, s42, v67
    v_fma_mix_f32 v132, s43, v248, 0 op_sel:[0,0,0] op_sel_hi:[0,1,0]
    v_fma_mix_f32 v133, s43, v248, 0 op_sel:[0,1,0] op_sel_hi:[0,1,0]
    v_fma_mix_f32 v134, s43, v249, 0 op_sel:[0,0,0] op_sel_hi:[0,1,0]
    v_fma_mix_f32 v135, s43, v249, 0 op_sel:[0,1,0] op_sel_hi:[0,1,0]
    s_branch L_re6
L_ro6:
    v_fma_mix_f32 v128, s42, v248, 0 op_sel:[0,0,0] op_sel_hi:[0,1,0]
    v_fma_mix_f32 v129, s42, v248, 0 op_sel:[0,1,0] op_sel_hi:[0,1,0]
    v_fma_mix_f32 v130, s42, v249, 0 op_sel:[0,0,0] op_sel_hi:[0,1,0]
    v_fma_mix_f32 v131, s42, v249, 0 op_sel:[0,1,0] op_sel_hi:[0,1,0]
    v_mul_f32 v132, s43, v72
    v_mul_f32 v133, s43, v73
    v_mul_f32 v134, s43, v74
    v_mul_f32 v135, s43, v75
L_re6:
    v_min_f32 v128, s44, v128
    v_min_f32 v129, s44, v129
    v_min_f32 v130, s44, v130
    v_min_f32 v131, s44, v131
    v_exp_f32 v132, v132
    v_exp_f32 v133, v133
    v_exp_f32 v134, v134
    v_exp_f32 v135, v135
    v_exp_f32 v128, v128
    v_exp_f32 v129, v129
    v_exp_f32 v130, v130
    v_exp_f32 v131, v131
    s_nop 0
    v_add_f32 v136, 1.0, v128
    v_add_f32 v137, 1.0, v129
    v_add_f32 v138, 1.0, v130
    v_add_f32 v139, 1.0, v131
    v_fma_f32 v136, v136, v132, v136
    v_fma_f32 v137, v137, v133, v137
    v_fma_f32 v138, v138, v134, v138
    v_fma_f32 v139, v139, v135, v139
    v_rcp_f32 v136, v136
    v_rcp_f32 v137, v137
    v_rcp_f32 v138, v138
    v_rcp_f32 v139, v139
    v_sub_f32 v128, 1.0, v128
    v_sub_f32 v129, 1.0, v129
    v_sub_f32 v130, 1.0, v130
    v_sub_f32 v131, 1.0, v131
    v_mul_f32 v140, v128, v136
    v_mul_f32 v141, v129, v137
    v_mul_f32 v142, v130, v138
    v_mul_f32 v143, v131, v139
    v_cvt_pk_bf16_f32 v156, v140, v141
    v_cvt_pk_bf16_f32 v157, v142, v143
    s_cbranch_vccnz L_ro7
    v_mul_f32 v128, s42, v68
    v_mul_f32 v129, s42, v69
    v_mul_f32 v130, s42, v70
    v_mul_f32 v131, s42, v71
    v_fma_mix_f32 v132, s43, v250, 0 op_sel:[0,0,0] op_sel_hi:[0,1,0]
    v_fma_mix_f32 v133, s43, v250, 0 op_sel:[0,1,0] op_sel_hi:[0,1,0]
    v_fma_mix_f32 v134, s43, v251, 0 op_sel:[0,0,0] op_sel_hi:[0,1,0]
    v_fma_mix_f32 v135, s43, v251, 0 op_sel:[0,1,0] op_sel_hi:[0,1,0]
    s_branch L_re7
L_ro7:
    v_fma_mix_f32 v128, s42, v250, 0 op_sel:[0,0,0] op_sel_hi:[0,1,0]
    v_fma_mix_f32 v129, s42, v250, 0 op_sel:[0,1,0] op_sel_hi:[0,1,0]
    v_fma_mix_f32 v130, s42, v251, 0 op_sel:[0,0,0] op_sel_hi:[0,1,0]
    v_fma_mix_f32 v131, s42, v251, 0 op_sel:[0,1,0] op_sel_hi:[0,1,0]
    v_mul_f32 v132, s43, v76
    v_mul_f32 v133, s43, v77
    v_mul_f32 v134, s43, v78
    v_mul_f32 v135, s43, v79
L_re7:
    v_min_f32 v128, s44, v128
    v_min_f32 v129, s44, v129
    v_min_f32 v130, s44, v130
    v_min_f32 v131, s44, v131
    v_exp_f32 v132, v132
    v_exp_f32 v133, v133
    v_exp_f32 v134, v134
    v_exp_f32 v135, v135
    v_exp_f32 v128, v128
    v_exp_f32 v129, v129
    v_exp_f32 v130, v130
    v_exp_f32 v131, v131
    s_nop 0
    v_add_f32 v136, 1.0, v128
    v_add_f32 v137, 1.0, v129
    v_add_f32 v138, 1.0, v130
    v_add_f32 v139, 1.0, v131
    v_fma_f32 v136, v136, v132, v136
    v_fma_f32 v137, v137, v133, v137
    v_fma_f32 v138, v138, v134, v138
    v_fma_f32 v139, v139, v135, v139
    v_rcp_f32 v136, v136
    v_rcp_f32 v137, v137
    v_rcp_f32 v138, v138
    v_rcp_f32 v139, v139
    v_sub_f32 v128, 1.0, v128
    v_sub_f32 v129, 1.0, v129
    v_sub_f32 v130, 1.0, v130
    v_sub_f32 v131, 1.0, v131
    v_mul_f32 v140, v128, v136
    v_mul_f32 v141, v129, v137
    v_mul_f32 v142, v130, v138
    v_mul_f32 v143, v131, v139
    v_cvt_pk_bf16_f32 v158, v140, v141
    v_cvt_pk_bf16_f32 v159, v142, v143
    ds_write_b128 v224, v[156:159] offset:4096
    s_waitcnt lgkmcnt(2)
    s_add_u32 m0, s56, 4032
    s_mov_b32 s35, 32768
    buffer_load_dwordx4 v231, s[20:23], s35 offen offset:64 lds
    s_add_u32 m0, s56, 5056
    s_mov_b32 s35, 40960
    buffer_load_dwordx4 v231, s[20:23], s35 offen offset:64 lds
    s_waitcnt vmcnt(5)
    ds_read_b64_tr_b16 v[184:185], v232 offset:0
    ds_read_b64_tr_b16 v[188:189], v232 offset:8
    s_waitcnt vmcnt(4)
    ds_read_b64_tr_b16 v[186:187], v232 offset:1024
    ds_read_b64_tr_b16 v[190:191], v232 offset:1032
    ds_read_b128 v[248:251], v224 offset:2048
    s_waitcnt lgkmcnt(6)
    s_cbranch_vccnz L_ro8
    v_mul_f32 v128, s42, v48
    v_mul_f32 v129, s42, v49
    v_mul_f32 v130, s42, v50
    v_mul_f32 v131, s42, v51
    v_fma_mix_f32 v132, s43, v252, 0 op_sel:[0,0,0] op_sel_hi:[0,1,0]
    v_fma_mix_f32 v133, s43, v252, 0 op_sel:[0,1,0] op_sel_hi:[0,1,0]
    v_fma_mix_f32 v134, s43, v253, 0 op_sel:[0,0,0] op_sel_hi:[0,1,0]
    v_fma_mix_f32 v135, s43, v253, 0 op_sel:[0,1,0] op_sel_hi:[0,1,0]
    s_branch L_re8
L_ro8:
    v_fma_mix_f32 v128, s42, v252, 0 op_sel:[0,0,0] op_sel_hi:[0,1,0]
    v_fma_mix_f32 v129, s42, v252, 0 op_sel:[0,1,0] op_sel_hi:[0,1,0]
    v_fma_mix_f32 v130, s42, v253, 0 op_sel:[0,0,0] op_sel_hi:[0,1,0]
    v_fma_mix_f32 v131, s42, v253, 0 op_sel:[0,1,0] op_sel_hi:[0,1,0]
    v_mul_f32 v132, s43, v56
    v_mul_f32 v133, s43, v57
    v_mul_f32 v134, s43, v58
    v_mul_f32 v135, s43, v59
L_re8:
    v_min_f32 v128, s44, v128
    v_min_f32 v129, s44, v129
    v_min_f32 v130, s44, v130
    v_min_f32 v131, s44, v131
    v_exp_f32 v132, v132
    v_exp_f32 v133, v133
    v_exp_f32 v134, v134
    v_exp_f32 v135, v135
    v_exp_f32 v128, v128
    v_exp_f32 v129, v129
    v_exp_f32 v130, v130
    v_exp_f32 v131, v131
    s_nop 0
    v_add_f32 v136, 1.0, v128
    v_add_f32 v137, 1.0, v129
    v_add_f32 v138, 1.0, v130
    v_add_f32 v139, 1.0, v131
    v_fma_f32 v136, v136, v132, v136
    v_fma_f32 v137, v137, v133, v137
    v_fma_f32 v138, v138, v134, v138
    v_fma_f32 v139, v139, v135, v139
    v_rcp_f32 v136, v136
    v_rcp_f32 v137, v137
    v_rcp_f32 v138, v138
    v_rcp_f32 v139, v139
    v_sub_f32 v128, 1.0, v128
    v_sub_f32 v129, 1.0, v129
    v_sub_f32 v130, 1.0, v130
    v_sub_f32 v131, 1.0, v131
    v_mul_f32 v140, v128, v136
    v_mul_f32 v141, v129, v137
    v_mul_f32 v142, v130, v138
    v_mul_f32 v143, v131, v139
    v_cvt_pk_bf16_f32 v144, v140, v141
    v_cvt_pk_bf16_f32 v145, v142, v143
    s_cbranch_vccnz L_ro9
    v_mul_f32 v128, s42, v52
    v_mul_f32 v129, s42, v53
    v_mul_f32 v130, s42, v54
    v_mul_f32 v131, s42, v55
    v_fma_mix_f32 v132, s43, v254, 0 op_sel:[0,0,0] op_sel_hi:[0,1,0]
    v_fma_mix_f32 v133, s43, v254, 0 op_sel:[0,1,0] op_sel_hi:[0,1,0]
    v_fma_mix_f32 v134, s43, v255, 0 op_sel:[0,0,0] op_sel_hi:[0,1,0]
    v_fma_mix_f32 v135, s43, v255, 0 op_sel:[0,1,0] op_sel_hi:[0,1,0]
    s_branch L_re9
L_ro9:
    v_fma_mix_f32 v128, s42, v254, 0 op_sel:[0,0,0] op_sel_hi:[0,1,0]
    v_fma_mix_f32 v129, s42, v254, 0 op_sel:[0,1,0] op_sel_hi:[0,1,0]
    v_fma_mix_f32 v130, s42, v255, 0 op_sel:[0,0,0] op_sel_hi:[0,1,0]
    v_fma_mix_f32 v131, s42, v255, 0 op_sel:[0,1,0] op_sel_hi:[0,1,0]
    v_mul_f32 v132, s43, v60
    v_mul_f32 v133, s43, v61
    v_mul_f32 v134, s43, v62
    v_mul_f32 v135, s43, v63
L_re9:
    v_min_f32 v128, s44, v128
    v_min_f32 v129, s44, v129
    v_min_f32 v130, s44, v130
    v_min_f32 v131, s44, v131
    v_exp_f32 v132, v132
    v_exp_f32 v133, v133
    v_exp_f32 v134, v134
    v_exp_f32 v135, v135
    v_exp_f32 v128, v128
    v_exp_f32 v129, v129
    v_exp_f32 v130, v130
    v_exp_f32 v131, v131
    s_nop 0
    v_add_f32 v136, 1.0, v128
    v_add_f32 v137, 1.0, v129
    v_add_f32 v138, 1.0, v130
    v_add_f32 v139, 1.0, v131
    v_fma_f32 v136, v136, v132, v136
    v_fma_f32 v137, v137, v133, v137
    v_fma_f32 v138, v138, v134, v138
    v_fma_f32 v139, v139, v135, v139
    v_rcp_f32 v136, v136
    v_rcp_f32 v137, v137
    v_rcp_f32 v138, v138
    v_rcp_f32 v139, v139
    v_sub_f32 v128, 1.0, v128
    v_sub_f32 v129, 1.0, v129
    v_sub_f32 v130, 1.0, v130
    v_sub_f32 v131, 1.0, v131
    v_mul_f32 v140, v128, v136
    v_mul_f32 v141, v129, v137
    v_mul_f32 v142, v130, v138
    v_mul_f32 v143, v131, v139
    v_cvt_pk_bf16_f32 v146, v140, v141
    v_cvt_pk_bf16_f32 v147, v142, v143
    ds_write_b128 v224, v[144:147] offset:3072
    s_waitcnt lgkmcnt(2)
    s_add_u32 m0, s56, 0
    s_mov_b32 s35, 49152
    buffer_load_dwordx4 v231, s[20:23], s35 offen offset:0 lds
    s_add_u32 m0, s56, 1024
    s_mov_b32 s35, 57344
    buffer_load_dwordx4 v231, s[20:23], s35 offen offset:0 lds
    s_waitcnt vmcnt(5)
    ds_read_b64_tr_b16 v[192:193], v232 offset:2048
    ds_read_b64_tr_b16 v[196:197], v232 offset:2056
    s_waitcnt vmcnt(4)
    ds_read_b64_tr_b16 v[194:195], v232 offset:3072
    ds_read_b64_tr_b16 v[198:199], v232 offset:3080
    ds_read_b128 v[252:255], v224 offset:1024
    s_waitcnt lgkmcnt(6)
    s_cbranch_vccnz L_ro10
    v_mul_f32 v128, s42, v32
    v_mul_f32 v129, s42, v33
    v_mul_f32 v130, s42, v34
    v_mul_f32 v131, s42, v35
    v_fma_mix_f32 v132, s43, v248, 0 op_sel:[0,0,0] op_sel_hi:[0,1,0]
    v_fma_mix_f32 v133, s43, v248, 0 op_sel:[0,1,0] op_sel_hi:[0,1,0]
    v_fma_mix_f32 v134, s43, v249, 0 op_sel:[0,0,0] op_sel_hi:[0,1,0]
    v_fma_mix_f32 v135, s43, v249, 0 op_sel:[0,1,0] op_sel_hi:[0,1,0]
    s_branch L_re10
L_ro10:
    v_fma_mix_f32 v128, s42, v248, 0 op_sel:[0,0,0] op_sel_hi:[0,1,0]
    v_fma_mix_f32 v129, s42, v248, 0 op_sel:[0,1,0] op_sel_hi:[0,1,0]
    v_fma_mix_f32 v130, s42, v249, 0 op_sel:[0,0,0] op_sel_hi:[0,1,0]
    v_fma_mix_f32 v131, s42, v249, 0 op_sel:[0,1,0] op_sel_hi:[0,1,0]
    v_mul_f32 v132, s43, v40
    v_mul_f32 v133, s43, v41
    v_mul_f32 v134, s43, v42
    v_mul_f32 v135, s43, v43
L_re10:
    v_min_f32 v128, s44, v128
    v_min_f32 v129, s44, v129
    v_min_f32 v130, s44, v130
    v_min_f32 v131, s44, v131
    v_exp_f32 v132, v132
    v_exp_f32 v133, v133
    v_exp_f32 v134, v134
    v_exp_f32 v135, v135
    v_exp_f32 v128, v128
    v_exp_f32 v129, v129
    v_exp_f32 v130, v130
    v_exp_f32 v131, v131
    s_nop 0
    v_add_f32 v136, 1.0, v128
    v_add_f32 v137, 1.0, v129
    v_add_f32 v138, 1.0, v130
    v_add_f32 v139, 1.0, v131
    v_fma_f32 v136, v136, v132, v136
    v_fma_f32 v137, v137, v133, v137
    v_fma_f32 v138, v138, v134, v138
    v_fma_f32 v139, v139, v135, v139
    v_rcp_f32 v136, v136
    v_rcp_f32 v137, v137
    v_rcp_f32 v138, v138
    v_rcp_f32 v139, v139
    v_sub_f32 v128, 1.0, v128
    v_sub_f32 v129, 1.0, v129
    v_sub_f32 v130, 1.0, v130
    v_sub_f32 v131, 1.0, v131
    v_mul_f32 v140, v128, v136
    v_mul_f32 v141, v129, v137
    v_mul_f32 v142, v130, v138
    v_mul_f32 v143, v131, v139
    v_cvt_pk_bf16_f32 v148, v140, v141
    v_cvt_pk_bf16_f32 v149, v142, v143
    s_cbranch_vccnz L_ro11
    v_mul_f32 v128, s42, v36
    v_mul_f32 v129, s42, v37
    v_mul_f32 v130, s42, v38
    v_mul_f32 v131, s42, v39
    v_fma_mix_f32 v132, s43, v250, 0 op_sel:[0,0,0] op_sel_hi:[0,1,0]
    v_fma_mix_f32 v133, s43, v250, 0 op_sel:[0,1,0] op_sel_hi:[0,1,0]
    v_fma_mix_f32 v134, s43, v251, 0 op_sel:[0,0,0] op_sel_hi:[0,1,0]
    v_fma_mix_f32 v135, s43, v251, 0 op_sel:[0,1,0] op_sel_hi:[0,1,0]
    s_branch L_re11
L_ro11:
    v_fma_mix_f32 v128, s42, v250, 0 op_sel:[0,0,0] op_sel_hi:[0,1,0]
    v_fma_mix_f32 v129, s42, v250, 0 op_sel:[0,1,0] op_sel_hi:[0,1,0]
    v_fma_mix_f32 v130, s42, v251, 0 op_sel:[0,0,0] op_sel_hi:[0,1,0]
    v_fma_mix_f32 v131, s42, v251, 0 op_sel:[0,1,0] op_sel_hi:[0,1,0]
    v_mul_f32 v132, s43, v44
    v_mul_f32 v133, s43, v45
    v_mul_f32 v134, s43, v46
    v_mul_f32 v135, s43, v47
L_re11:
    v_min_f32 v128, s44, v128
    v_min_f32 v129, s44, v129
    v_min_f32 v130, s44, v130
    v_min_f32 v131, s44, v131
    v_exp_f32 v132, v132
    v_exp_f32 v133, v133
    v_exp_f32 v134, v134
    v_exp_f32 v135, v135
    v_exp_f32 v128, v128
    v_exp_f32 v129, v129
    v_exp_f32 v130, v130
    v_exp_f32 v131, v131
    s_nop 0
    v_add_f32 v136, 1.0, v128
    v_add_f32 v137, 1.0, v129
    v_add_f32 v138, 1.0, v130
    v_add_f32 v139, 1.0, v131
    v_fma_f32 v136, v136, v132, v136
    v_fma_f32 v137, v137, v133, v137
    v_fma_f32 v138, v138, v134, v138
    v_fma_f32 v139, v139, v135, v139
    v_rcp_f32 v136, v136
    v_rcp_f32 v137, v137
    v_rcp_f32 v138, v138
    v_rcp_f32 v139, v139
    v_sub_f32 v128, 1.0, v128
    v_sub_f32 v129, 1.0, v129
    v_sub_f32 v130, 1.0, v130
    v_sub_f32 v131, 1.0, v131
    v_mul_f32 v140, v128, v136
    v_mul_f32 v141, v129, v137
    v_mul_f32 v142, v130, v138
    v_mul_f32 v143, v131, v139
    v_cvt_pk_bf16_f32 v150, v140, v141
    v_cvt_pk_bf16_f32 v151, v142, v143
    ds_write_b128 v224, v[148:151] offset:2048
    s_waitcnt lgkmcnt(2)
    s_add_u32 m0, s56, 1984
    s_mov_b32 s35, 49152
    buffer_load_dwordx4 v231, s[20:23], s35 offen offset:64 lds
    s_add_u32 m0, s56, 3008
    s_mov_b32 s35, 57344
    buffer_load_dwordx4 v231, s[20:23], s35 offen offset:64 lds
    s_waitcnt vmcnt(5)
    ds_read_b64_tr_b16 v[200:201], v232 offset:4096
    ds_read_b64_tr_b16 v[204:205], v232 offset:4104
    s_waitcnt vmcnt(4)
    ds_read_b64_tr_b16 v[202:203], v232 offset:5120
    ds_read_b64_tr_b16 v[206:207], v232 offset:5128
    ds_read_b128 v[248:251], v224 offset:0
    s_waitcnt lgkmcnt(6)
    s_cbranch_vccnz L_ro12
    v_mul_f32 v128, s42, v16
    v_mul_f32 v129, s42, v17
    v_mul_f32 v130, s42, v18
    v_mul_f32 v131, s42, v19
    v_fma_mix_f32 v132, s43, v252, 0 op_sel:[0,0,0] op_sel_hi:[0,1,0]
    v_fma_mix_f32 v133, s43, v252, 0 op_sel:[0,1,0] op_sel_hi:[0,1,0]
    v_fma_mix_f32 v134, s43, v253, 0 op_sel:[0,0,0] op_sel_hi:[0,1,0]
    v_fma_mix_f32 v135, s43, v253, 0 op_sel:[0,1,0] op_sel_hi:[0,1,0]
    s_branch L_re12
L_ro12:
    v_fma_mix_f32 v128, s42, v252, 0 op_sel:[0,0,0] op_sel_hi:[0,1,0]
    v_fma_mix_f32 v129, s42, v252, 0 op_sel:[0,1,0] op_sel_hi:[0,1,0]
    v_fma_mix_f32 v130, s42, v253, 0 op_sel:[0,0,0] op_sel_hi:[0,1,0]
    v_fma_mix_f32 v131, s42, v253, 0 op_sel:[0,1,0] op_sel_hi:[0,1,0]
    v_mul_f32 v132, s43, v24
    v_mul_f32 v133, s43, v25
    v_mul_f32 v134, s43, v26
    v_mul_f32 v135, s43, v27
L_re12:
    v_min_f32 v128, s44, v128
    v_min_f32 v129, s44, v129
    v_min_f32 v130, s44, v130
    v_min_f32 v131, s44, v131
    v_exp_f32 v132, v132
    v_exp_f32 v133, v133
    v_exp_f32 v134, v134
    v_exp_f32 v135, v135
    v_exp_f32 v128, v128
    v_exp_f32 v129, v129
    v_exp_f32 v130, v130
    v_exp_f32 v131, v131
    s_nop 0
    v_add_f32 v136, 1.0, v128
    v_add_f32 v137, 1.0, v129
    v_add_f32 v138, 1.0, v130
    v_add_f32 v139, 1.0, v131
    v_fma_f32 v136, v136, v132, v136
    v_fma_f32 v137, v137, v133, v137
    v_fma_f32 v138, v138, v134, v138
    v_fma_f32 v139, v139, v135, v139
    v_rcp_f32 v136, v136
    v_rcp_f32 v137, v137
    v_rcp_f32 v138, v138
    v_rcp_f32 v139, v139
    v_sub_f32 v128, 1.0, v128
    v_sub_f32 v129, 1.0, v129
    v_sub_f32 v130, 1.0, v130
    v_sub_f32 v131, 1.0, v131
    v_mul_f32 v140, v128, v136
    v_mul_f32 v141, v129, v137
    v_mul_f32 v142, v130, v138
    v_mul_f32 v143, v131, v139
    v_cvt_pk_bf16_f32 v152, v140, v141
    v_cvt_pk_bf16_f32 v153, v142, v143
    s_cbranch_vccnz L_ro13
    v_mul_f32 v128, s42, v20
    v_mul_f32 v129, s42, v21
    v_mul_f32 v130, s42, v22
    v_mul_f32 v131, s42, v23
    v_fma_mix_f32 v132, s43, v254, 0 op_sel:[0,0,0] op_sel_hi:[0,1,0]
    v_fma_mix_f32 v133, s43, v254, 0 op_sel:[0,1,0] op_sel_hi:[0,1,0]
    v_fma_mix_f32 v134, s43, v255, 0 op_sel:[0,0,0] op_sel_hi:[0,1,0]
    v_fma_mix_f32 v135, s43, v255, 0 op_sel:[0,1,0] op_sel_hi:[0,1,0]
    s_branch L_re13
L_ro13:
    v_fma_mix_f32 v128, s42, v254, 0 op_sel:[0,0,0] op_sel_hi:[0,1,0]
    v_fma_mix_f32 v129, s42, v254, 0 op_sel:[0,1,0] op_sel_hi:[0,1,0]
    v_fma_mix_f32 v130, s42, v255, 0 op_sel:[0,0,0] op_sel_hi:[0,1,0]
    v_fma_mix_f32 v131, s42, v255, 0 op_sel:[0,1,0] op_sel_hi:[0,1,0]
    v_mul_f32 v132, s43, v28
    v_mul_f32 v133, s43, v29
    v_mul_f32 v134, s43, v30
    v_mul_f32 v135, s43, v31
L_re13:
    v_min_f32 v128, s44, v128
    v_min_f32 v129, s44, v129
    v_min_f32 v130, s44, v130
    v_min_f32 v131, s44, v131
    v_exp_f32 v132, v132
    v_exp_f32 v133, v133
    v_exp_f32 v134, v134
    v_exp_f32 v135, v135
    v_exp_f32 v128, v128
    v_exp_f32 v129, v129
    v_exp_f32 v130, v130
    v_exp_f32 v131, v131
    s_nop 0
    v_add_f32 v136, 1.0, v128
    v_add_f32 v137, 1.0, v129
    v_add_f32 v138, 1.0, v130
    v_add_f32 v139, 1.0, v131
    v_fma_f32 v136, v136, v132, v136
    v_fma_f32 v137, v137, v133, v137
    v_fma_f32 v138, v138, v134, v138
    v_fma_f32 v139, v139, v135, v139
    v_rcp_f32 v136, v136
    v_rcp_f32 v137, v137
    v_rcp_f32 v138, v138
    v_rcp_f32 v139, v139
    v_sub_f32 v128, 1.0, v128
    v_sub_f32 v129, 1.0, v129
    v_sub_f32 v130, 1.0, v130
    v_sub_f32 v131, 1.0, v131
    v_mul_f32 v140, v128, v136
    v_mul_f32 v141, v129, v137
    v_mul_f32 v142, v130, v138
    v_mul_f32 v143, v131, v139
    v_cvt_pk_bf16_f32 v154, v140, v141
    v_cvt_pk_bf16_f32 v155, v142, v143
    ds_write_b128 v224, v[152:155] offset:1024
    s_waitcnt lgkmcnt(2)
    s_add_u32 m0, s56, 4096
    s_mov_b32 s35, 65536
    buffer_load_dwordx4 v231, s[20:23], s35 offen offset:0 lds
    s_add_u32 m0, s56, 5120
    s_mov_b32 s35, 73728
    buffer_load_dwordx4 v231, s[20:23], s35 offen offset:0 lds
    s_waitcnt vmcnt(5)
    ds_read_b64_tr_b16 v[208:209], v232 offset:0
    ds_read_b64_tr_b16 v[212:213], v232 offset:8
    s_waitcnt vmcnt(4)
    ds_read_b64_tr_b16 v[210:211], v232 offset:1024
    ds_read_b64_tr_b16 v[214:215], v232 offset:1032
    s_waitcnt lgkmcnt(5)
    s_cbranch_vccnz L_ro14
    v_mul_f32 v128, s42, v0
    v_mul_f32 v129, s42, v1
    v_mul_f32 v130, s42, v2
    v_mul_f32 v131, s42, v3
    v_fma_mix_f32 v132, s43, v248, 0 op_sel:[0,0,0] op_sel_hi:[0,1,0]
    v_fma_mix_f32 v133, s43, v248, 0 op_sel:[0,1,0] op_sel_hi:[0,1,0]
    v_fma_mix_f32 v134, s43, v249, 0 op_sel:[0,0,0] op_sel_hi:[0,1,0]
    v_fma_mix_f32 v135, s43, v249, 0 op_sel:[0,1,0] op_sel_hi:[0,1,0]
    s_branch L_re14
L_ro14:
    v_fma_mix_f32 v128, s42, v248, 0 op_sel:[0,0,0] op_sel_hi:[0,1,0]
    v_fma_mix_f32 v129, s42, v248, 0 op_sel:[0,1,0] op_sel_hi:[0,1,0]
    v_fma_mix_f32 v130, s42, v249, 0 op_sel:[0,0,0] op_sel_hi:[0,1,0]
    v_fma_mix_f32 v131, s42, v249, 0 op_sel:[0,1,0] op_sel_hi:[0,1,0]
    v_mul_f32 v132, s43, v8
    v_mul_f32 v133, s43, v9
    v_mul_f32 v134, s43, v10
    v_mul_f32 v135, s43, v11
L_re14:
    v_min_f32 v128, s44, v128
    v_min_f32 v129, s44, v129
    v_min_f32 v130, s44, v130
    v_min_f32 v131, s44, v131
    v_exp_f32 v132, v132
    v_exp_f32 v133, v133
    v_exp_f32 v134, v134
    v_exp_f32 v135, v135
    v_exp_f32 v128, v128
    v_exp_f32 v129, v129
    v_exp_f32 v130, v130
    v_exp_f32 v131, v131
    s_nop 0
    v_add_f32 v136, 1.0, v128
    v_add_f32 v137, 1.0, v129
    v_add_f32 v138, 1.0, v130
    v_add_f32 v139, 1.0, v131
    v_fma_f32 v136, v136, v132, v136
    v_fma_f32 v137, v137, v133, v137
    v_fma_f32 v138, v138, v134, v138
    v_fma_f32 v139, v139, v135, v139
    v_rcp_f32 v136, v136
    v_rcp_f32 v137, v137
    v_rcp_f32 v138, v138
    v_rcp_f32 v139, v139
    v_sub_f32 v128, 1.0, v128
    v_sub_f32 v129, 1.0, v129
    v_sub_f32 v130, 1.0, v130
    v_sub_f32 v131, 1.0, v131
    v_mul_f32 v140, v128, v136
    v_mul_f32 v141, v129, v137
    v_mul_f32 v142, v130, v138
    v_mul_f32 v143, v131, v139
    v_cvt_pk_bf16_f32 v156, v140, v141
    v_cvt_pk_bf16_f32 v157, v142, v143
    s_cbranch_vccnz L_ro15
    v_mul_f32 v128, s42, v4
    v_mul_f32 v129, s42, v5
    v_mul_f32 v130, s42, v6
    v_mul_f32 v131, s42, v7
    v_fma_mix_f32 v132, s43, v250, 0 op_sel:[0,0,0] op_sel_hi:[0,1,0]
    v_fma_mix_f32 v133, s43, v250, 0 op_sel:[0,1,0] op_sel_hi:[0,1,0]
    v_fma_mix_f32 v134, s43, v251, 0 op_sel:[0,0,0] op_sel_hi:[0,1,0]
    v_fma_mix_f32 v135, s43, v251, 0 op_sel:[0,1,0] op_sel_hi:[0,1,0]
    s_branch L_re15
L_ro15:
    v_fma_mix_f32 v128, s42, v250, 0 op_sel:[0,0,0] op_sel_hi:[0,1,0]
    v_fma_mix_f32 v129, s42, v250, 0 op_sel:[0,1,0] op_sel_hi:[0,1,0]
    v_fma_mix_f32 v130, s42, v251, 0 op_sel:[0,0,0] op_sel_hi:[0,1,0]
    v_fma_mix_f32 v131, s42, v251, 0 op_sel:[0,1,0] op_sel_hi:[0,1,0]
    v_mul_f32 v132, s43, v12
    v_mul_f32 v133, s43, v13
    v_mul_f32 v134, s43, v14
    v_mul_f32 v135, s43, v15
L_re15:
    v_min_f32 v128, s44, v128
    v_min_f32 v129, s44, v129
    v_min_f32 v130, s44, v130
    v_min_f32 v131, s44, v131
    v_exp_f32 v132, v132
    v_exp_f32 v133, v133
    v_exp_f32 v134, v134
    v_exp_f32 v135, v135
    v_exp_f32 v128, v128
    v_exp_f32 v129, v129
    v_exp_f32 v130, v130
    v_exp_f32 v131, v131
    s_nop 0
    v_add_f32 v136, 1.0, v128
    v_add_f32 v137, 1.0, v129
    v_add_f32 v138, 1.0, v130
    v_add_f32 v139, 1.0, v131
    v_fma_f32 v136, v136, v132, v136
    v_fma_f32 v137, v137, v133, v137
    v_fma_f32 v138, v138, v134, v138
    v_fma_f32 v139, v139, v135, v139
    v_rcp_f32 v136, v136
    v_rcp_f32 v137, v137
    v_rcp_f32 v138, v138
    v_rcp_f32 v139, v139
    v_sub_f32 v128, 1.0, v128
    v_sub_f32 v129, 1.0, v129
    v_sub_f32 v130, 1.0, v130
    v_sub_f32 v131, 1.0, v131
    v_mul_f32 v140, v128, v136
    v_mul_f32 v141, v129, v137
    v_mul_f32 v142, v130, v138
    v_mul_f32 v143, v131, v139
    v_cvt_pk_bf16_f32 v158, v140, v141
    v_cvt_pk_bf16_f32 v159, v142, v143
    ds_write_b128 v224, v[156:159] offset:0
    s_waitcnt lgkmcnt(1)
    s_sub_u32 m0, s56, 64
    s_mov_b32 s35, 65536
    buffer_load_dwordx4 v231, s[20:23], s35 offen offset:64 lds
    s_add_u32 m0, s56, 960
    s_mov_b32 s35, 73728
    buffer_load_dwordx4 v231, s[20:23], s35 offen offset:64 lds
    s_waitcnt vmcnt(5)
    ds_read_b64_tr_b16 v[216:217], v232 offset:2048
    ds_read_b64_tr_b16 v[220:221], v232 offset:2056
    s_waitcnt vmcnt(4)
    ds_read_b64_tr_b16 v[218:219], v232 offset:3072
    ds_read_b64_tr_b16 v[222:223], v232 offset:3080
    s_mov_b64 exec, 1
    ds_add_u32 v239, v237 offset:32
    s_mov_b64 exec, -1
    s_waitcnt lgkmcnt(1)
    s_add_u32 m0, s56, 2048
    s_mov_b32 s35, 81920
    buffer_load_dwordx4 v231, s[20:23], s35 offen offset:0 lds
    s_add_u32 m0, s56, 3072
    s_mov_b32 s35, 90112
    buffer_load_dwordx4 v231, s[20:23], s35 offen offset:0 lds
L_zhs:
    ds_read_b32 v236, v239 offset:32
    s_waitcnt lgkmcnt(0)
    v_readfirstlane_b32 s36, v236
    s_cmp_eq_u32 s36, 4
    s_cbranch_scc0 L_zhs
    ds_read_b128 v[156:159], v229 offset:15360
    ds_read_b128 v[152:155], v229 offset:14336
    ds_read_b128 v[148:151], v229 offset:13312
    ds_read_b128 v[144:147], v229 offset:12288
    ds_read_b128 v[140:143], v229 offset:11264
    ds_read_b128 v[136:139], v229 offset:10240
    ds_read_b128 v[132:135], v229 offset:9216
    ds_read_b128 v[128:131], v229 offset:8192
    s_waitcnt lgkmcnt(7)
    v_mfma_f32_16x16x32_bf16 v[112:115], v[160:163], v[156:159], 0
    v_mfma_f32_16x16x32_bf16 v[116:119], v[164:167], v[156:159], 0
    v_mfma_f32_16x16x32_bf16 v[120:123], v[168:171], v[156:159], 0
    v_mfma_f32_16x16x32_bf16 v[124:127], v[172:175], v[156:159], 0
    ds_read_b128 v[156:159], v229 offset:7168
    s_waitcnt lgkmcnt(7)
    v_mfma_f32_16x16x32_bf16 v[96:99], v[160:163], v[152:155], 0
    v_mfma_f32_16x16x32_bf16 v[100:103], v[164:167], v[152:155], 0
    v_mfma_f32_16x16x32_bf16 v[104:107], v[168:171], v[152:155], 0
    v_mfma_f32_16x16x32_bf16 v[108:111], v[172:175], v[152:155], 0
    ds_read_b128 v[152:155], v229 offset:6144
    s_waitcnt lgkmcnt(7)
    v_mfma_f32_16x16x32_bf16 v[80:83], v[160:163], v[148:151], 0
    v_mfma_f32_16x16x32_bf16 v[84:87], v[164:167], v[148:151], 0
    v_mfma_f32_16x16x32_bf16 v[88:91], v[168:171], v[148:151], 0
    v_mfma_f32_16x16x32_bf16 v[92:95], v[172:175], v[148:151], 0
    ds_read_b128 v[148:151], v229 offset:5120
    s_waitcnt lgkmcnt(7)
    v_mfma_f32_16x16x32_bf16 v[64:67], v[160:163], v[144:147], 0
    v_mfma_f32_16x16x32_bf16 v[68:71], v[164:167], v[144:147], 0
    v_mfma_f32_16x16x32_bf16 v[72:75], v[168:171], v[144:147], 0
    v_mfma_f32_16x16x32_bf16 v[76:79], v[172:175], v[144:147], 0
    ds_read_b128 v[144:147], v229 offset:4096
    s_waitcnt lgkmcnt(7)
    v_mfma_f32_16x16x32_bf16 v[48:51], v[160:163], v[140:143], 0
    v_mfma_f32_16x16x32_bf16 v[52:55], v[164:167], v[140:143], 0
    v_mfma_f32_16x16x32_bf16 v[56:59], v[168:171], v[140:143], 0
    v_mfma_f32_16x16x32_bf16 v[60:63], v[172:175], v[140:143], 0
    ds_read_b128 v[140:143], v229 offset:3072
    s_waitcnt lgkmcnt(7)
    v_mfma_f32_16x16x32_bf16 v[32:35], v[160:163], v[136:139], 0
    v_mfma_f32_16x16x32_bf16 v[36:39], v[164:167], v[136:139], 0
    v_mfma_f32_16x16x32_bf16 v[40:43], v[168:171], v[136:139], 0
    v_mfma_f32_16x16x32_bf16 v[44:47], v[172:175], v[136:139], 0
    ds_read_b128 v[136:139], v229 offset:2048
    s_waitcnt lgkmcnt(7)
    v_mfma_f32_16x16x32_bf16 v[16:19], v[160:163], v[132:135], 0
    v_mfma_f32_16x16x32_bf16 v[20:23], v[164:167], v[132:135], 0
    v_mfma_f32_16x16x32_bf16 v[24:27], v[168:171], v[132:135], 0
    v_mfma_f32_16x16x32_bf16 v[28:31], v[172:175], v[132:135], 0
    ds_read_b128 v[132:135], v229 offset:1024
    s_waitcnt lgkmcnt(7)
    v_mfma_f32_16x16x32_bf16 v[0:3], v[160:163], v[128:131], 0
    v_mfma_f32_16x16x32_bf16 v[4:7], v[164:167], v[128:131], 0
    v_mfma_f32_16x16x32_bf16 v[8:11], v[168:171], v[128:131], 0
    v_mfma_f32_16x16x32_bf16 v[12:15], v[172:175], v[128:131], 0
    ds_read_b128 v[128:131], v229 offset:0
    s_waitcnt lgkmcnt(7)
    v_mfma_f32_16x16x32_bf16 v[112:115], v[176:179], v[156:159], v[112:115]
    s_waitcnt vmcnt(5)
    ds_read_b64_tr_b16 v[160:161], v232 offset:4096
    ds_read_b64_tr_b16 v[164:165], v232 offset:4104
    v_mfma_f32_16x16x32_bf16 v[116:119], v[180:183], v[156:159], v[116:119]
    v_mfma_f32_16x16x32_bf16 v[120:123], v[184:187], v[156:159], v[120:123]
    v_mfma_f32_16x16x32_bf16 v[124:127], v[188:191], v[156:159], v[124:127]
    ds_read_b128 v[156:159], v229 offset:31744
    s_waitcnt lgkmcnt(9)
    v_mfma_f32_16x16x32_bf16 v[96:99], v[176:179], v[152:155], v[96:99]
    v_mfma_f32_16x16x32_bf16 v[100:103], v[180:183], v[152:155], v[100:103]
    v_mfma_f32_16x16x32_bf16 v[104:107], v[184:187], v[152:155], v[104:107]
    s_waitcnt lgkmcnt(1)
    s_add_u32 m0, s56, 4032
    s_mov_b32 s35, 81920
    buffer_load_dwordx4 v231, s[20:23], s35 offen offset:64 lds
    v_mfma_f32_16x16x32_bf16 v[108:111], v[188:191], v[152:155], v[108:111]
    ds_read_b128 v[152:155], v229 offset:30720
    v_mfma_f32_16x16x32_bf16 v[80:83], v[176:179], v[148:151], v[80:83]
    s_waitcnt vmcnt(5)
    ds_read_b64_tr_b16 v[162:163], v232 offset:5120
    ds_read_b64_tr_b16 v[166:167], v232 offset:5128
    v_mfma_f32_16x16x32_bf16 v[84:87], v[180:183], v[148:151], v[84:87]
    v_mfma_f32_16x16x32_bf16 v[88:91], v[184:187], v[148:151], v[88:91]
    v_mfma_f32_16x16x32_bf16 v[92:95], v[188:191], v[148:151], v[92:95]
    ds_read_b128 v[148:151], v229 offset:29696
    v_mfma_f32_16x16x32_bf16 v[64:67], v[176:179], v[144:147], v[64:67]
    v_mfma_f32_16x16x32_bf16 v[68:71], v[180:183], v[144:147], v[68:71]
    v_mfma_f32_16x16x32_bf16 v[72:75], v[184:187], v[144:147], v[72:75]
    s_waitcnt lgkmcnt(1)
    s_add_u32 m0, s56, 5056
    s_mov_b32 s35, 90112
    buffer_load_dwordx4 v231, s[20:23], s35 offen offset:64 lds
    v_mfma_f32_16x16x32_bf16 v[76:79], v[188:191], v[144:147], v[76:79]
    ds_read_b128 v[144:147], v229 offset:28672
    v_mfma_f32_16x16x32_bf16 v[48:51], v[176:179], v[140:143], v[48:51]
    s_waitcnt vmcnt(5)
    ds_read_b64_tr_b16 v[168:169], v232 offset:0
    ds_read_b64_tr_b16 v[172:173], v232 offset:8
    v_mfma_f32_16x16x32_bf16 v[52:55], v[180:183], v[140:143], v[52:55]
    v_mfma_f32_16x16x32_bf16 v[56:59], v[184:187], v[140:143], v[56:59]
    v_mfma_f32_16x16x32_bf16 v[60:63], v[188:191], v[140:143], v[60:63]
    ds_read_b128 v[140:143], v229 offset:27648
    v_mfma_f32_16x16x32_bf16 v[32:35], v[176:179], v[136:139], v[32:35]
    v_mfma_f32_16x16x32_bf16 v[36:39], v[180:183], v[136:139], v[36:39]
    v_mfma_f32_16x16x32_bf16 v[40:43], v[184:187], v[136:139], v[40:43]
    s_waitcnt lgkmcnt(1)
    s_add_u32 m0, s56, 0
    s_mov_b32 s35, 98304
    buffer_load_dwordx4 v231, s[20:23], s35 offen offset:0 lds
    v_mfma_f32_16x16x32_bf16 v[44:47], v[188:191], v[136:139], v[44:47]
    ds_read_b128 v[136:139], v229 offset:26624
    v_mfma_f32_16x16x32_bf16 v[16:19], v[176:179], v[132:135], v[16:19]
    s_waitcnt vmcnt(5)
    ds_read_b64_tr_b16 v[170:171], v232 offset:1024
    ds_read_b64_tr_b16 v[174:175], v232 offset:1032
    v_mfma_f32_16x16x32_bf16 v[20:23], v[180:183], v[132:135], v[20:23]
    v_mfma_f32_16x16x32_bf16 v[24:27], v[184:187], v[132:135], v[24:27]
    v_mfma_f32_16x16x32_bf16 v[28:31], v[188:191], v[132:135], v[28:31]
    ds_read_b128 v[132:135], v229 offset:25600
    v_mfma_f32_16x16x32_bf16 v[0:3], v[176:179], v[128:131], v[0:3]
    v_mfma_f32_16x16x32_bf16 v[4:7], v[180:183], v[128:131], v[4:7]
    v_mfma_f32_16x16x32_bf16 v[8:11], v[184:187], v[128:131], v[8:11]
    s_waitcnt lgkmcnt(1)
    s_add_u32 m0, s56, 1024
    s_mov_b32 s35, 106496
    buffer_load_dwordx4 v231, s[20:23], s35 offen offset:0 lds
    v_mfma_f32_16x16x32_bf16 v[12:15], v[188:191], v[128:131], v[12:15]
    ds_read_b128 v[128:131], v229 offset:24576
    v_mfma_f32_16x16x32_bf16 v[112:115], v[192:195], v[156:159], v[112:115]
    s_waitcnt vmcnt(5)
    ds_read_b64_tr_b16 v[176:177], v232 offset:2048
    ds_read_b64_tr_b16 v[180:181], v232 offset:2056
    v_mfma_f32_16x16x32_bf16 v[116:119], v[196:199], v[156:159], v[116:119]
    v_mfma_f32_16x16x32_bf16 v[120:123], v[200:203], v[156:159], v[120:123]
    v_mfma_f32_16x16x32_bf16 v[124:127], v[204:207], v[156:159], v[124:127]
    ds_read_b128 v[156:159], v229 offset:23552
    v_mfma_f32_16x16x32_bf16 v[96:99], v[192:195], v[152:155], v[96:99]
    v_mfma_f32_16x16x32_bf16 v[100:103], v[196:199], v[152:155], v[100:103]
    v_mfma_f32_16x16x32_bf16 v[104:107], v[200:203], v[152:155], v[104:107]
    s_waitcnt lgkmcnt(1)
    s_add_u32 m0, s56, 1984
    s_mov_b32 s35, 98304
    buffer_load_dwordx4 v231, s[20:23], s35 offen offset:64 lds
    v_mfma_f32_16x16x32_bf16 v[108:111], v[204:207], v[152:155], v[108:111]
    ds_read_b128 v[152:155], v229 offset:22528
    v_mfma_f32_16x16x32_bf16 v[80:83], v[192:195], v[148:151], v[80:83]
    s_waitcnt vmcnt(5)
    ds_read_b64_tr_b16 v[178:179], v232 offset:3072
    ds_read_b64_tr_b16 v[182:183], v232 offset:3080
    v_mfma_f32_16x16x32_bf16 v[84:87], v[196:199], v[148:151], v[84:87]
    v_mfma_f32_16x16x32_bf16 v[88:91], v[200:203], v[148:151], v[88:91]
    v_mfma_f32_16x16x32_bf16 v[92:95], v[204:207], v[148:151], v[92:95]
    ds_read_b128 v[148:151], v229 offset:21504
    v_mfma_f32_16x16x32_bf16 v[64:67], v[192:195], v[144:147], v[64:67]
    v_mfma_f32_16x16x32_bf16 v[68:71], v[196:199], v[144:147], v[68:71]
    v_mfma_f32_16x16x32_bf16 v[72:75], v[200:203], v[144:147], v[72:75]
    s_waitcnt lgkmcnt(1)
    s_add_u32 m0, s56, 3008
    s_mov_b32 s35, 106496
    buffer_load_dwordx4 v231, s[20:23], s35 offen offset:64 lds
    v_mfma_f32_16x16x32_bf16 v[76:79], v[204:207], v[144:147], v[76:79]
    ds_read_b128 v[144:147], v229 offset:20480
    v_mfma_f32_16x16x32_bf16 v[48:51], v[192:195], v[140:143], v[48:51]
    s_waitcnt vmcnt(5)
    ds_read_b64_tr_b16 v[184:185], v232 offset:4096
    ds_read_b64_tr_b16 v[188:189], v232 offset:4104
    v_mfma_f32_16x16x32_bf16 v[52:55], v[196:199], v[140:143], v[52:55]
    v_mfma_f32_16x16x32_bf16 v[56:59], v[200:203], v[140:143], v[56:59]
    v_mfma_f32_16x16x32_bf16 v[60:63], v[204:207], v[140:143], v[60:63]
    ds_read_b128 v[140:143], v229 offset:19456
    v_mfma_f32_16x16x32_bf16 v[32:35], v[192:195], v[136:139], v[32:35]
    v_mfma_f32_16x16x32_bf16 v[36:39], v[196:199], v[136:139], v[36:39]
    v_mfma_f32_16x16x32_bf16 v[40:43], v[200:203], v[136:139], v[40:43]
    s_waitcnt lgkmcnt(1)
    s_add_u32 m0, s56, 4096
    s_mov_b32 s35, 114688
    buffer_load_dwordx4 v231, s[20:23], s35 offen offset:0 lds
    v_mfma_f32_16x16x32_bf16 v[44:47], v[204:207], v[136:139], v[44:47]
    ds_read_b128 v[136:139], v229 offset:18432
    v_mfma_f32_16x16x32_bf16 v[16:19], v[192:195], v[132:135], v[16:19]
    s_waitcnt vmcnt(5)
    ds_read_b64_tr_b16 v[186:187], v232 offset:5120
    ds_read_b64_tr_b16 v[190:191], v232 offset:5128
    v_mfma_f32_16x16x32_bf16 v[20:23], v[196:199], v[132:135], v[20:23]
    v_mfma_f32_16x16x32_bf16 v[24:27], v[200:203], v[132:135], v[24:27]
    v_mfma_f32_16x16x32_bf16 v[28:31], v[204:207], v[132:135], v[28:31]
    ds_read_b128 v[132:135], v229 offset:17408
    v_mfma_f32_16x16x32_bf16 v[0:3], v[192:195], v[128:131], v[0:3]
    v_mfma_f32_16x16x32_bf16 v[4:7], v[196:199], v[128:131], v[4:7]
    v_mfma_f32_16x16x32_bf16 v[8:11], v[200:203], v[128:131], v[8:11]
    s_waitcnt lgkmcnt(1)
    s_add_u32 m0, s56, 5120
    s_mov_b32 s35, 122880
    buffer_load_dwordx4 v231, s[20:23], s35 offen offset:0 lds
    v_mfma_f32_16x16x32_bf16 v[12:15], v[204:207], v[128:131], v[12:15]
    ds_read_b128 v[128:131], v229 offset:16384
    v_mfma_f32_16x16x32_bf16 v[112:115], v[208:211], v[156:159], v[112:115]
    s_waitcnt vmcnt(5)
    ds_read_b64_tr_b16 v[192:193], v232 offset:0
    ds_read_b64_tr_b16 v[196:197], v232 offset:8
    v_mfma_f32_16x16x32_bf16 v[116:119], v[212:215], v[156:159], v[116:119]
    v_mfma_f32_16x16x32_bf16 v[120:123], v[216:219], v[156:159], v[120:123]
    v_mfma_f32_16x16x32_bf16 v[124:127], v[220:223], v[156:159], v[124:127]
    v_mfma_f32_16x16x32_bf16 v[96:99], v[208:211], v[152:155], v[96:99]
    v_mfma_f32_16x16x32_bf16 v[100:103], v[212:215], v[152:155], v[100:103]
    v_mfma_f32_16x16x32_bf16 v[104:107], v[216:219], v[152:155], v[104:107]
    s_waitcnt lgkmcnt(0)
    s_sub_u32 m0, s56, 64
    s_mov_b32 s35, 114688
    buffer_load_dwordx4 v231, s[20:23], s35 offen offset:64 lds
    v_mfma_f32_16x16x32_bf16 v[108:111], v[220:223], v[152:155], v[108:111]
    v_mfma_f32_16x16x32_bf16 v[80:83], v[208:211], v[148:151], v[80:83]
    s_waitcnt vmcnt(5)
    ds_read_b64_tr_b16 v[194:195], v232 offset:1024
    ds_read_b64_tr_b16 v[198:199], v232 offset:1032
    v_mfma_f32_16x16x32_bf16 v[84:87], v[212:215], v[148:151], v[84:87]
    v_mfma_f32_16x16x32_bf16 v[88:91], v[216:219], v[148:151], v[88:91]
    v_mfma_f32_16x16x32_bf16 v[92:95], v[220:223], v[148:151], v[92:95]
    v_mfma_f32_16x16x32_bf16 v[64:67], v[208:211], v[144:147], v[64:67]
    v_mfma_f32_16x16x32_bf16 v[68:71], v[212:215], v[144:147], v[68:71]
    v_mfma_f32_16x16x32_bf16 v[72:75], v[216:219], v[144:147], v[72:75]
    s_waitcnt lgkmcnt(0)
    s_add_u32 m0, s56, 960
    s_mov_b32 s35, 122880
    buffer_load_dwordx4 v231, s[20:23], s35 offen offset:64 lds
    v_mfma_f32_16x16x32_bf16 v[76:79], v[220:223], v[144:147], v[76:79]
    v_mfma_f32_16x16x32_bf16 v[48:51], v[208:211], v[140:143], v[48:51]
    s_waitcnt vmcnt(5)
    ds_read_b64_tr_b16 v[200:201], v232 offset:2048
    ds_read_b64_tr_b16 v[204:205], v232 offset:2056
    v_mfma_f32_16x16x32_bf16 v[52:55], v[212:215], v[140:143], v[52:55]
    v_mfma_f32_16x16x32_bf16 v[56:59], v[216:219], v[140:143], v[56:59]
    v_mfma_f32_16x16x32_bf16 v[60:63], v[220:223], v[140:143], v[60:63]
    v_mfma_f32_16x16x32_bf16 v[32:35], v[208:211], v[136:139], v[32:35]
    v_mfma_f32_16x16x32_bf16 v[36:39], v[212:215], v[136:139], v[36:39]
    v_mfma_f32_16x16x32_bf16 v[40:43], v[216:219], v[136:139], v[40:43]
    v_mfma_f32_16x16x32_bf16 v[44:47], v[220:223], v[136:139], v[44:47]
    v_mfma_f32_16x16x32_bf16 v[16:19], v[208:211], v[132:135], v[16:19]
    s_waitcnt vmcnt(4)
    ds_read_b64_tr_b16 v[202:203], v232 offset:3072
    ds_read_b64_tr_b16 v[206:207], v232 offset:3080
    v_mfma_f32_16x16x32_bf16 v[20:23], v[212:215], v[132:135], v[20:23]
    v_mfma_f32_16x16x32_bf16 v[24:27], v[216:219], v[132:135], v[24:27]
    v_mfma_f32_16x16x32_bf16 v[28:31], v[220:223], v[132:135], v[28:31]
    v_mfma_f32_16x16x32_bf16 v[0:3], v[208:211], v[128:131], v[0:3]
    v_mfma_f32_16x16x32_bf16 v[4:7], v[212:215], v[128:131], v[4:7]
    v_mfma_f32_16x16x32_bf16 v[8:11], v[216:219], v[128:131], v[8:11]
    v_mfma_f32_16x16x32_bf16 v[12:15], v[220:223], v[128:131], v[12:15]
    s_waitcnt vmcnt(3)
    ds_read_b64_tr_b16 v[208:209], v232 offset:4096
    ds_read_b64_tr_b16 v[212:213], v232 offset:4104
    s_waitcnt vmcnt(2)
    ds_read_b64_tr_b16 v[210:211], v232 offset:5120
    ds_read_b64_tr_b16 v[214:215], v232 offset:5128
    s_waitcnt vmcnt(1)
    ds_read_b64_tr_b16 v[216:217], v232 offset:0
    ds_read_b64_tr_b16 v[220:221], v232 offset:8
    s_waitcnt vmcnt(0)
    ds_read_b64_tr_b16 v[218:219], v232 offset:1024
    ds_read_b64_tr_b16 v[222:223], v232 offset:1032
    s_lshr_b32 s39, s2, 3
    s_and_b32 s39, s39, 7
    s_mov_b32 s34, 0
    s_cmp_eq_u32 s39, 1
    s_cbranch_scc1 L_zl6
    s_cmp_eq_u32 s39, 2
    s_cbranch_scc1 L_zl5
    s_cmp_eq_u32 s39, 3
    s_cbranch_scc1 L_zl4
    s_cmp_eq_u32 s39, 4
    s_cbranch_scc1 L_zl3
    s_cmp_eq_u32 s39, 5
    s_cbranch_scc1 L_zl2
    s_cmp_eq_u32 s39, 6
    s_cbranch_scc1 L_zl1
    s_cmp_eq_u32 s39, 7
    s_cbranch_scc1 L_zl0
L_zl7:
    ds_read_b32 v236, v239 offset:92
    ds_read_b128 v[128:131], v229 offset:48128
    ds_read_b128 v[132:135], v229 offset:39936
    ds_read_b128 v[136:139], v229 offset:64512
    ds_read_b128 v[140:143], v229 offset:56320
    s_waitcnt lgkmcnt(0)
    v_readfirstlane_b32 s36, v236
    s_cmp_eq_u32 s36, 4
    s_cbranch_scc0 L_zl7
    v_mfma_f32_16x16x32_bf16 v[112:115], v[160:163], v[128:131], v[112:115]
    v_mfma_f32_16x16x32_bf16 v[116:119], v[164:167], v[128:131], v[116:119]
    v_mfma_f32_16x16x32_bf16 v[120:123], v[168:171], v[128:131], v[120:123]
    v_mfma_f32_16x16x32_bf16 v[124:127], v[172:175], v[128:131], v[124:127]
    v_mfma_f32_16x16x32_bf16 v[112:115], v[176:179], v[132:135], v[112:115]
    v_mfma_f32_16x16x32_bf16 v[116:119], v[180:183], v[132:135], v[116:119]
    v_mfma_f32_16x16x32_bf16 v[120:123], v[184:187], v[132:135], v[120:123]
    v_mfma_f32_16x16x32_bf16 v[124:127], v[188:191], v[132:135], v[124:127]
    v_mfma_f32_16x16x32_bf16 v[112:115], v[192:195], v[136:139], v[112:115]
    v_mfma_f32_16x16x32_bf16 v[116:119], v[196:199], v[136:139], v[116:119]
    v_mfma_f32_16x16x32_bf16 v[120:123], v[200:203], v[136:139], v[120:123]
    v_mfma_f32_16x16x32_bf16 v[124:127], v[204:207], v[136:139], v[124:127]
    v_mfma_f32_16x16x32_bf16 v[112:115], v[208:211], v[140:143], v[112:115]
    v_mfma_f32_16x16x32_bf16 v[116:119], v[212:215], v[140:143], v[116:119]
    v_mfma_f32_16x16x32_bf16 v[120:123], v[216:219], v[140:143], v[120:123]
    v_mfma_f32_16x16x32_bf16 v[124:127], v[220:223], v[140:143], v[124:127]
    s_nop 7
    v_cvt_pk_bf16_f32 v240, v112, v113
    v_cvt_pk_bf16_f32 v241, v114, v115
    v_cvt_pk_bf16_f32 v242, v116, v117
    v_cvt_pk_bf16_f32 v243, v118, v119
    buffer_store_dwordx4 v[240:243], v233, s[24:27], s40 offen offset:3584 sc1
    v_cvt_pk_bf16_f32 v244, v120, v121
    v_cvt_pk_bf16_f32 v245, v122, v123
    v_cvt_pk_bf16_f32 v246, v124, v125
    v_cvt_pk_bf16_f32 v247, v126, v127
    buffer_store_dwordx4 v[244:247], v233, s[24:27], s40 offen offset:3648 sc1
    s_add_u32 s34, s34, 1
    s_cmp_eq_u32 s34, 8
    s_cbranch_scc1 L_zdone
L_zl6:
    ds_read_b32 v236, v239 offset:88
    ds_read_b128 v[144:147], v229 offset:47104
    ds_read_b128 v[148:151], v229 offset:38912
    ds_read_b128 v[152:155], v229 offset:63488
    ds_read_b128 v[156:159], v229 offset:55296
    s_waitcnt lgkmcnt(0)
    v_readfirstlane_b32 s36, v236
    s_cmp_eq_u32 s36, 4
    s_cbranch_scc0 L_zl6
    v_mfma_f32_16x16x32_bf16 v[96:99], v[160:163], v[144:147], v[96:99]
    v_mfma_f32_16x16x32_bf16 v[100:103], v[164:167], v[144:147], v[100:103]
    v_mfma_f32_16x16x32_bf16 v[104:107], v[168:171], v[144:147], v[104:107]
    v_mfma_f32_16x16x32_bf16 v[108:111], v[172:175], v[144:147], v[108:111]
    v_mfma_f32_16x16x32_bf16 v[96:99], v[176:179], v[148:151], v[96:99]
    v_mfma_f32_16x16x32_bf16 v[100:103], v[180:183], v[148:151], v[100:103]
    v_mfma_f32_16x16x32_bf16 v[104:107], v[184:187], v[148:151], v[104:107]
    v_mfma_f32_16x16x32_bf16 v[108:111], v[188:191], v[148:151], v[108:111]
    v_mfma_f32_16x16x32_bf16 v[96:99], v[192:195], v[152:155], v[96:99]
    v_mfma_f32_16x16x32_bf16 v[100:103], v[196:199], v[152:155], v[100:103]
    v_mfma_f32_16x16x32_bf16 v[104:107], v[200:203], v[152:155], v[104:107]
    v_mfma_f32_16x16x32_bf16 v[108:111], v[204:207], v[152:155], v[108:111]
    v_mfma_f32_16x16x32_bf16 v[96:99], v[208:211], v[156:159], v[96:99]
    v_mfma_f32_16x16x32_bf16 v[100:103], v[212:215], v[156:159], v[100:103]
    v_mfma_f32_16x16x32_bf16 v[104:107], v[216:219], v[156:159], v[104:107]
    v_mfma_f32_16x16x32_bf16 v[108:111], v[220:223], v[156:159], v[108:111]
    s_nop 7
    v_cvt_pk_bf16_f32 v248, v96, v97
    v_cvt_pk_bf16_f32 v249, v98, v99
    v_cvt_pk_bf16_f32 v250, v100, v101
    v_cvt_pk_bf16_f32 v251, v102, v103
    buffer_store_dwordx4 v[248:251], v233, s[24:27], s40 offen offset:3072 sc1
    v_cvt_pk_bf16_f32 v252, v104, v105
    v_cvt_pk_bf16_f32 v253, v106, v107
    v_cvt_pk_bf16_f32 v254, v108, v109
    v_cvt_pk_bf16_f32 v255, v110, v111
    buffer_store_dwordx4 v[252:255], v233, s[24:27], s40 offen offset:3136 sc1
    s_add_u32 s34, s34, 1
    s_cmp_eq_u32 s34, 8
    s_cbranch_scc1 L_zdone
L_zl5:
    ds_read_b32 v236, v239 offset:84
    ds_read_b128 v[128:131], v229 offset:46080
    ds_read_b128 v[132:135], v229 offset:37888
    ds_read_b128 v[136:139], v229 offset:62464
    ds_read_b128 v[140:143], v229 offset:54272
    s_waitcnt lgkmcnt(0)
    v_readfirstlane_b32 s36, v236
    s_cmp_eq_u32 s36, 4
    s_cbranch_scc0 L_zl5
    v_mfma_f32_16x16x32_bf16 v[80:83], v[160:163], v[128:131], v[80:83]
    v_mfma_f32_16x16x32_bf16 v[84:87], v[164:167], v[128:131], v[84:87]
    v_mfma_f32_16x16x32_bf16 v[88:91], v[168:171], v[128:131], v[88:91]
    v_mfma_f32_16x16x32_bf16 v[92:95], v[172:175], v[128:131], v[92:95]
    v_mfma_f32_16x16x32_bf16 v[80:83], v[176:179], v[132:135], v[80:83]
    v_mfma_f32_16x16x32_bf16 v[84:87], v[180:183], v[132:135], v[84:87]
    v_mfma_f32_16x16x32_bf16 v[88:91], v[184:187], v[132:135], v[88:91]
    v_mfma_f32_16x16x32_bf16 v[92:95], v[188:191], v[132:135], v[92:95]
    v_mfma_f32_16x16x32_bf16 v[80:83], v[192:195], v[136:139], v[80:83]
    v_mfma_f32_16x16x32_bf16 v[84:87], v[196:199], v[136:139], v[84:87]
    v_mfma_f32_16x16x32_bf16 v[88:91], v[200:203], v[136:139], v[88:91]
    v_mfma_f32_16x16x32_bf16 v[92:95], v[204:207], v[136:139], v[92:95]
    v_mfma_f32_16x16x32_bf16 v[80:83], v[208:211], v[140:143], v[80:83]
    v_mfma_f32_16x16x32_bf16 v[84:87], v[212:215], v[140:143], v[84:87]
    v_mfma_f32_16x16x32_bf16 v[88:91], v[216:219], v[140:143], v[88:91]
    v_mfma_f32_16x16x32_bf16 v[92:95], v[220:223], v[140:143], v[92:95]
    s_nop 7
    v_cvt_pk_bf16_f32 v240, v80, v81
    v_cvt_pk_bf16_f32 v241, v82, v83
    v_cvt_pk_bf16_f32 v242, v84, v85
    v_cvt_pk_bf16_f32 v243, v86, v87
    buffer_store_dwordx4 v[240:243], v233, s[24:27], s40 offen offset:2560 sc1
    v_cvt_pk_bf16_f32 v244, v88, v89
    v_cvt_pk_bf16_f32 v245, v90, v91
    v_cvt_pk_bf16_f32 v246, v92, v93
    v_cvt_pk_bf16_f32 v247, v94, v95
    buffer_store_dwordx4 v[244:247], v233, s[24:27], s40 offen offset:2624 sc1
    s_add_u32 s34, s34, 1
    s_cmp_eq_u32 s34, 8
    s_cbranch_scc1 L_zdone
L_zl4:
    ds_read_b32 v236, v239 offset:80
    ds_read_b128 v[144:147], v229 offset:45056
    ds_read_b128 v[148:151], v229 offset:36864
    ds_read_b128 v[152:155], v229 offset:61440
    ds_read_b128 v[156:159], v229 offset:53248
    s_waitcnt lgkmcnt(0)
    v_readfirstlane_b32 s36, v236
    s_cmp_eq_u32 s36, 4
    s_cbranch_scc0 L_zl4
    v_mfma_f32_16x16x32_bf16 v[64:67], v[160:163], v[144:147], v[64:67]
    v_mfma_f32_16x16x32_bf16 v[68:71], v[164:167], v[144:147], v[68:71]
    v_mfma_f32_16x16x32_bf16 v[72:75], v[168:171], v[144:147], v[72:75]
    v_mfma_f32_16x16x32_bf16 v[76:79], v[172:175], v[144:147], v[76:79]
    v_mfma_f32_16x16x32_bf16 v[64:67], v[176:179], v[148:151], v[64:67]
    v_mfma_f32_16x16x32_bf16 v[68:71], v[180:183], v[148:151], v[68:71]
    v_mfma_f32_16x16x32_bf16 v[72:75], v[184:187], v[148:151], v[72:75]
    v_mfma_f32_16x16x32_bf16 v[76:79], v[188:191], v[148:151], v[76:79]
    v_mfma_f32_16x16x32_bf16 v[64:67], v[192:195], v[152:155], v[64:67]
    v_mfma_f32_16x16x32_bf16 v[68:71], v[196:199], v[152:155], v[68:71]
    v_mfma_f32_16x16x32_bf16 v[72:75], v[200:203], v[152:155], v[72:75]
    v_mfma_f32_16x16x32_bf16 v[76:79], v[204:207], v[152:155], v[76:79]
    v_mfma_f32_16x16x32_bf16 v[64:67], v[208:211], v[156:159], v[64:67]
    v_mfma_f32_16x16x32_bf16 v[68:71], v[212:215], v[156:159], v[68:71]
    v_mfma_f32_16x16x32_bf16 v[72:75], v[216:219], v[156:159], v[72:75]
    v_mfma_f32_16x16x32_bf16 v[76:79], v[220:223], v[156:159], v[76:79]
    s_nop 7
    v_cvt_pk_bf16_f32 v248, v64, v65
    v_cvt_pk_bf16_f32 v249, v66, v67
    v_cvt_pk_bf16_f32 v250, v68, v69
    v_cvt_pk_bf16_f32 v251, v70, v71
    buffer_store_dwordx4 v[248:251], v233, s[24:27], s40 offen offset:2048 sc1
    v_cvt_pk_bf16_f32 v252, v72, v73
    v_cvt_pk_bf16_f32 v253, v74, v75
    v_cvt_pk_bf16_f32 v254, v76, v77
    v_cvt_pk_bf16_f32 v255, v78, v79
    buffer_store_dwordx4 v[252:255], v233, s[24:27], s40 offen offset:2112 sc1
    s_add_u32 s34, s34, 1
    s_cmp_eq_u32 s34, 8
    s_cbranch_scc1 L_zdone
L_zl3:
    ds_read_b32 v236, v239 offset:76
    ds_read_b128 v[128:131], v229 offset:44032
    ds_read_b128 v[132:135], v229 offset:35840
    ds_read_b128 v[136:139], v229 offset:60416
    ds_read_b128 v[140:143], v229 offset:52224
    s_waitcnt lgkmcnt(0)
    v_readfirstlane_b32 s36, v236
    s_cmp_eq_u32 s36, 4
    s_cbranch_scc0 L_zl3
    v_mfma_f32_16x16x32_bf16 v[48:51], v[160:163], v[128:131], v[48:51]
    v_mfma_f32_16x16x32_bf16 v[52:55], v[164:167], v[128:131], v[52:55]
    v_mfma_f32_16x16x32_bf16 v[56:59], v[168:171], v[128:131], v[56:59]
    v_mfma_f32_16x16x32_bf16 v[60:63], v[172:175], v[128:131], v[60:63]
    v_mfma_f32_16x16x32_bf16 v[48:51], v[176:179], v[132:135], v[48:51]
    v_mfma_f32_16x16x32_bf16 v[52:55], v[180:183], v[132:135], v[52:55]
    v_mfma_f32_16x16x32_bf16 v[56:59], v[184:187], v[132:135], v[56:59]
    v_mfma_f32_16x16x32_bf16 v[60:63], v[188:191], v[132:135], v[60:63]
    v_mfma_f32_16x16x32_bf16 v[48:51], v[192:195], v[136:139], v[48:51]
    v_mfma_f32_16x16x32_bf16 v[52:55], v[196:199], v[136:139], v[52:55]
    v_mfma_f32_16x16x32_bf16 v[56:59], v[200:203], v[136:139], v[56:59]
    v_mfma_f32_16x16x32_bf16 v[60:63], v[204:207], v[136:139], v[60:63]
    v_mfma_f32_16x16x32_bf16 v[48:51], v[208:211], v[140:143], v[48:51]
    v_mfma_f32_16x16x32_bf16 v[52:55], v[212:215], v[140:143], v[52:55]
    v_mfma_f32_16x16x32_bf16 v[56:59], v[216:219], v[140:143], v[56:59]
    v_mfma_f32_16x16x32_bf16 v[60:63], v[220:223], v[140:143], v[60:63]
    s_nop 7
    v_cvt_pk_bf16_f32 v240, v48, v49
    v_cvt_pk_bf16_f32 v241, v50, v51
    v_cvt_pk_bf16_f32 v242, v52, v53
    v_cvt_pk_bf16_f32 v243, v54, v55
    buffer_store_dwordx4 v[240:243], v233, s[24:27], s40 offen offset:1536 sc1
    v_cvt_pk_bf16_f32 v244, v56, v57
    v_cvt_pk_bf16_f32 v245, v58, v59
    v_cvt_pk_bf16_f32 v246, v60, v61
    v_cvt_pk_bf16_f32 v247, v62, v63
    buffer_store_dwordx4 v[244:247], v233, s[24:27], s40 offen offset:1600 sc1
    s_add_u32 s34, s34, 1
    s_cmp_eq_u32 s34, 8
    s_cbranch_scc1 L_zdone
L_zl2:
    ds_read_b32 v236, v239 offset:72
    ds_read_b128 v[144:147], v229 offset:43008
    ds_read_b128 v[148:151], v229 offset:34816
    ds_read_b128 v[152:155], v229 offset:59392
    ds_read_b128 v[156:159], v229 offset:51200
    s_waitcnt lgkmcnt(0)
    v_readfirstlane_b32 s36, v236
    s_cmp_eq_u32 s36, 4
    s_cbranch_scc0 L_zl2
    v_mfma_f32_16x16x32_bf16 v[32:35], v[160:163], v[144:147], v[32:35]
    v_mfma_f32_16x16x32_bf16 v[36:39], v[164:167], v[144:147], v[36:39]
    v_mfma_f32_16x16x32_bf16 v[40:43], v[168:171], v[144:147], v[40:43]
    v_mfma_f32_16x16x32_bf16 v[44:47], v[172:175], v[144:147], v[44:47]
    v_mfma_f32_16x16x32_bf16 v[32:35], v[176:179], v[148:151], v[32:35]
    v_mfma_f32_16x16x32_bf16 v[36:39], v[180:183], v[148:151], v[36:39]
    v_mfma_f32_16x16x32_bf16 v[40:43], v[184:187], v[148:151], v[40:43]
    v_mfma_f32_16x16x32_bf16 v[44:47], v[188:191], v[148:151], v[44:47]
    v_mfma_f32_16x16x32_bf16 v[32:35], v[192:195], v[152:155], v[32:35]
    v_mfma_f32_16x16x32_bf16 v[36:39], v[196:199], v[152:155], v[36:39]
    v_mfma_f32_16x16x32_bf16 v[40:43], v[200:203], v[152:155], v[40:43]
    v_mfma_f32_16x16x32_bf16 v[44:47], v[204:207], v[152:155], v[44:47]
    v_mfma_f32_16x16x32_bf16 v[32:35], v[208:211], v[156:159], v[32:35]
    v_mfma_f32_16x16x32_bf16 v[36:39], v[212:215], v[156:159], v[36:39]
    v_mfma_f32_16x16x32_bf16 v[40:43], v[216:219], v[156:159], v[40:43]
    v_mfma_f32_16x16x32_bf16 v[44:47], v[220:223], v[156:159], v[44:47]
    s_nop 7
    v_cvt_pk_bf16_f32 v248, v32, v33
    v_cvt_pk_bf16_f32 v249, v34, v35
    v_cvt_pk_bf16_f32 v250, v36, v37
    v_cvt_pk_bf16_f32 v251, v38, v39
    buffer_store_dwordx4 v[248:251], v233, s[24:27], s40 offen offset:1024 sc1
    v_cvt_pk_bf16_f32 v252, v40, v41
    v_cvt_pk_bf16_f32 v253, v42, v43
    v_cvt_pk_bf16_f32 v254, v44, v45
    v_cvt_pk_bf16_f32 v255, v46, v47
    buffer_store_dwordx4 v[252:255], v233, s[24:27], s40 offen offset:1088 sc1
    s_add_u32 s34, s34, 1
    s_cmp_eq_u32 s34, 8
    s_cbranch_scc1 L_zdone
L_zl1:
    ds_read_b32 v236, v239 offset:68
    ds_read_b128 v[128:131], v229 offset:41984
    ds_read_b128 v[132:135], v229 offset:33792
    ds_read_b128 v[136:139], v229 offset:58368
    ds_read_b128 v[140:143], v229 offset:50176
    s_waitcnt lgkmcnt(0)
    v_readfirstlane_b32 s36, v236
    s_cmp_eq_u32 s36, 4
    s_cbranch_scc0 L_zl1
    v_mfma_f32_16x16x32_bf16 v[16:19], v[160:163], v[128:131], v[16:19]
    v_mfma_f32_16x16x32_bf16 v[20:23], v[164:167], v[128:131], v[20:23]
    v_mfma_f32_16x16x32_bf16 v[24:27], v[168:171], v[128:131], v[24:27]
    v_mfma_f32_16x16x32_bf16 v[28:31], v[172:175], v[128:131], v[28:31]
    v_mfma_f32_16x16x32_bf16 v[16:19], v[176:179], v[132:135], v[16:19]
    v_mfma_f32_16x16x32_bf16 v[20:23], v[180:183], v[132:135], v[20:23]
    v_mfma_f32_16x16x32_bf16 v[24:27], v[184:187], v[132:135], v[24:27]
    v_mfma_f32_16x16x32_bf16 v[28:31], v[188:191], v[132:135], v[28:31]
    v_mfma_f32_16x16x32_bf16 v[16:19], v[192:195], v[136:139], v[16:19]
    v_mfma_f32_16x16x32_bf16 v[20:23], v[196:199], v[136:139], v[20:23]
    v_mfma_f32_16x16x32_bf16 v[24:27], v[200:203], v[136:139], v[24:27]
    v_mfma_f32_16x16x32_bf16 v[28:31], v[204:207], v[136:139], v[28:31]
    v_mfma_f32_16x16x32_bf16 v[16:19], v[208:211], v[140:143], v[16:19]
    v_mfma_f32_16x16x32_bf16 v[20:23], v[212:215], v[140:143], v[20:23]
    v_mfma_f32_16x16x32_bf16 v[24:27], v[216:219], v[140:143], v[24:27]
    v_mfma_f32_16x16x32_bf16 v[28:31], v[220:223], v[140:143], v[28:31]
    s_nop 7
    v_cvt_pk_bf16_f32 v240, v16, v17
    v_cvt_pk_bf16_f32 v241, v18, v19
    v_cvt_pk_bf16_f32 v242, v20, v21
    v_cvt_pk_bf16_f32 v243, v22, v23
    buffer_store_dwordx4 v[240:243], v233, s[24:27], s40 offen offset:512 sc1
    v_cvt_pk_bf16_f32 v244, v24, v25
    v_cvt_pk_bf16_f32 v245, v26, v27
    v_cvt_pk_bf16_f32 v246, v28, v29
    v_cvt_pk_bf16_f32 v247, v30, v31
    buffer_store_dwordx4 v[244:247], v233, s[24:27], s40 offen offset:576 sc1
    s_add_u32 s34, s34, 1
    s_cmp_eq_u32 s34, 8
    s_cbranch_scc1 L_zdone
L_zl0:
    ds_read_b32 v236, v239 offset:64
    ds_read_b128 v[144:147], v229 offset:40960
    ds_read_b128 v[148:151], v229 offset:32768
    ds_read_b128 v[152:155], v229 offset:57344
    ds_read_b128 v[156:159], v229 offset:49152
    s_waitcnt lgkmcnt(0)
    v_readfirstlane_b32 s36, v236
    s_cmp_eq_u32 s36, 4
    s_cbranch_scc0 L_zl0
    v_mfma_f32_16x16x32_bf16 v[0:3], v[160:163], v[144:147], v[0:3]
    v_mfma_f32_16x16x32_bf16 v[4:7], v[164:167], v[144:147], v[4:7]
    v_mfma_f32_16x16x32_bf16 v[8:11], v[168:171], v[144:147], v[8:11]
    v_mfma_f32_16x16x32_bf16 v[12:15], v[172:175], v[144:147], v[12:15]
    v_mfma_f32_16x16x32_bf16 v[0:3], v[176:179], v[148:151], v[0:3]
    v_mfma_f32_16x16x32_bf16 v[4:7], v[180:183], v[148:151], v[4:7]
    v_mfma_f32_16x16x32_bf16 v[8:11], v[184:187], v[148:151], v[8:11]
    v_mfma_f32_16x16x32_bf16 v[12:15], v[188:191], v[148:151], v[12:15]
    v_mfma_f32_16x16x32_bf16 v[0:3], v[192:195], v[152:155], v[0:3]
    v_mfma_f32_16x16x32_bf16 v[4:7], v[196:199], v[152:155], v[4:7]
    v_mfma_f32_16x16x32_bf16 v[8:11], v[200:203], v[152:155], v[8:11]
    v_mfma_f32_16x16x32_bf16 v[12:15], v[204:207], v[152:155], v[12:15]
    v_mfma_f32_16x16x32_bf16 v[0:3], v[208:211], v[156:159], v[0:3]
    v_mfma_f32_16x16x32_bf16 v[4:7], v[212:215], v[156:159], v[4:7]
    v_mfma_f32_16x16x32_bf16 v[8:11], v[216:219], v[156:159], v[8:11]
    v_mfma_f32_16x16x32_bf16 v[12:15], v[220:223], v[156:159], v[12:15]
    s_nop 7
    v_cvt_pk_bf16_f32 v248, v0, v1
    v_cvt_pk_bf16_f32 v249, v2, v3
    v_cvt_pk_bf16_f32 v250, v4, v5
    v_cvt_pk_bf16_f32 v251, v6, v7
    buffer_store_dwordx4 v[248:251], v233, s[24:27], s40 offen offset:0 sc1
    v_cvt_pk_bf16_f32 v252, v8, v9
    v_cvt_pk_bf16_f32 v253, v10, v11
    v_cvt_pk_bf16_f32 v254, v12, v13
    v_cvt_pk_bf16_f32 v255, v14, v15
    buffer_store_dwordx4 v[252:255], v233, s[24:27], s40 offen offset:64 sc1
    s_add_u32 s34, s34, 1
    s_cmp_eq_u32 s34, 8
    s_cbranch_scc0 L_zl7
L_zdone:
    s_endpgm
L_low:
    s_setprio 3
L_xpl:
    ds_read_b32 v236, v242 offset:0
    s_waitcnt lgkmcnt(0)
    v_readfirstlane_b32 s36, v236
    s_cmp_eq_u32 s36, 1
    s_cbranch_scc0 L_xpl
    s_lshr_b32 s39, s2, 3
    s_and_b32 s39, s39, 7
    s_mov_b32 s34, 0
    s_cmp_eq_u32 s39, 1
    s_cbranch_scc1 L_gs6
    s_cmp_eq_u32 s39, 2
    s_cbranch_scc1 L_gs5
    s_cmp_eq_u32 s39, 3
    s_cbranch_scc1 L_gs4
    s_cmp_eq_u32 s39, 4
    s_cbranch_scc1 L_gs3
    s_cmp_eq_u32 s39, 5
    s_cbranch_scc1 L_gs2
    s_cmp_eq_u32 s39, 6
    s_cbranch_scc1 L_gs1
    s_cmp_eq_u32 s39, 7
    s_cbranch_scc1 L_gs0
L_gs7:
    ds_read_b128 v[252:255], v224 offset:7168
    s_branch L_gl7
L_gs6:
    ds_read_b128 v[248:251], v224 offset:6144
    s_branch L_gl6
L_gs5:
    ds_read_b128 v[252:255], v224 offset:5120
    s_branch L_gl5
L_gs4:
    ds_read_b128 v[248:251], v224 offset:4096
    s_branch L_gl4
L_gs3:
    ds_read_b128 v[252:255], v224 offset:3072
    s_branch L_gl3
L_gs2:
    ds_read_b128 v[248:251], v224 offset:2048
    s_branch L_gl2
L_gs1:
    ds_read_b128 v[252:255], v224 offset:1024
    s_branch L_gl1
L_gs0:
    ds_read_b128 v[248:251], v224 offset:0
    s_branch L_gl0
L_gl7:
    ds_read_b128 v[248:251], v224 offset:6144
    s_waitcnt lgkmcnt(1)
    s_cbranch_vccnz L_ro16
    v_mul_f32 v128, s42, v112
    v_mul_f32 v129, s42, v113
    v_mul_f32 v130, s42, v114
    v_mul_f32 v131, s42, v115
    v_fma_mix_f32 v132, s43, v252, 0 op_sel:[0,0,0] op_sel_hi:[0,1,0]
    v_fma_mix_f32 v133, s43, v252, 0 op_sel:[0,1,0] op_sel_hi:[0,1,0]
    v_fma_mix_f32 v134, s43, v253, 0 op_sel:[0,0,0] op_sel_hi:[0,1,0]
    v_fma_mix_f32 v135, s43, v253, 0 op_sel:[0,1,0] op_sel_hi:[0,1,0]
    s_branch L_re16
L_ro16:
    v_fma_mix_f32 v128, s42, v252, 0 op_sel:[0,0,0] op_sel_hi:[0,1,0]
    v_fma_mix_f32 v129, s42, v252, 0 op_sel:[0,1,0] op_sel_hi:[0,1,0]
    v_fma_mix_f32 v130, s42, v253, 0 op_sel:[0,0,0] op_sel_hi:[0,1,0]
    v_fma_mix_f32 v131, s42, v253, 0 op_sel:[0,1,0] op_sel_hi:[0,1,0]
    v_mul_f32 v132, s43, v120
    v_mul_f32 v133, s43, v121
    v_mul_f32 v134, s43, v122
    v_mul_f32 v135, s43, v123
L_re16:
    v_min_f32 v128, s44, v128
    v_min_f32 v129, s44, v129
    v_min_f32 v130, s44, v130
    v_min_f32 v131, s44, v131
    v_exp_f32 v132, v132
    v_exp_f32 v133, v133
    v_exp_f32 v134, v134
    v_exp_f32 v135, v135
    v_exp_f32 v128, v128
    v_exp_f32 v129, v129
    v_exp_f32 v130, v130
    v_exp_f32 v131, v131
    s_nop 0
    v_add_f32 v136, 1.0, v128
    v_add_f32 v137, 1.0, v129
    v_add_f32 v138, 1.0, v130
    v_add_f32 v139, 1.0, v131
    v_fma_f32 v136, v136, v132, v136
    v_fma_f32 v137, v137, v133, v137
    v_fma_f32 v138, v138, v134, v138
    v_fma_f32 v139, v139, v135, v139
    v_rcp_f32 v136, v136
    v_rcp_f32 v137, v137
    v_rcp_f32 v138, v138
    v_rcp_f32 v139, v139
    v_sub_f32 v128, 1.0, v128
    v_sub_f32 v129, 1.0, v129
    v_sub_f32 v130, 1.0, v130
    v_sub_f32 v131, 1.0, v131
    v_mul_f32 v140, v128, v136
    v_mul_f32 v141, v129, v137
    v_mul_f32 v142, v130, v138
    v_mul_f32 v143, v131, v139
    v_cvt_pk_bf16_f32 v144, v140, v141
    v_cvt_pk_bf16_f32 v145, v142, v143
    s_cbranch_vccnz L_ro17
    v_mul_f32 v128, s42, v116
    v_mul_f32 v129, s42, v117
    v_mul_f32 v130, s42, v118
    v_mul_f32 v131, s42, v119
    v_fma_mix_f32 v132, s43, v254, 0 op_sel:[0,0,0] op_sel_hi:[0,1,0]
    v_fma_mix_f32 v133, s43, v254, 0 op_sel:[0,1,0] op_sel_hi:[0,1,0]
    v_fma_mix_f32 v134, s43, v255, 0 op_sel:[0,0,0] op_sel_hi:[0,1,0]
    v_fma_mix_f32 v135, s43, v255, 0 op_sel:[0,1,0] op_sel_hi:[0,1,0]
    s_branch L_re17
L_ro17:
    v_fma_mix_f32 v128, s42, v254, 0 op_sel:[0,0,0] op_sel_hi:[0,1,0]
    v_fma_mix_f32 v129, s42, v254, 0 op_sel:[0,1,0] op_sel_hi:[0,1,0]
    v_fma_mix_f32 v130, s42, v255, 0 op_sel:[0,0,0] op_sel_hi:[0,1,0]
    v_fma_mix_f32 v131, s42, v255, 0 op_sel:[0,1,0] op_sel_hi:[0,1,0]
    v_mul_f32 v132, s43, v124
    v_mul_f32 v133, s43, v125
    v_mul_f32 v134, s43, v126
    v_mul_f32 v135, s43, v127
L_re17:
    v_min_f32 v128, s44, v128
    v_min_f32 v129, s44, v129
    v_min_f32 v130, s44, v130
    v_min_f32 v131, s44, v131
    v_exp_f32 v132, v132
    v_exp_f32 v133, v133
    v_exp_f32 v134, v134
    v_exp_f32 v135, v135
    v_exp_f32 v128, v128
    v_exp_f32 v129, v129
    v_exp_f32 v130, v130
    v_exp_f32 v131, v131
    s_nop 0
    v_add_f32 v136, 1.0, v128
    v_add_f32 v137, 1.0, v129
    v_add_f32 v138, 1.0, v130
    v_add_f32 v139, 1.0, v131
    v_fma_f32 v136, v136, v132, v136
    v_fma_f32 v137, v137, v133, v137
    v_fma_f32 v138, v138, v134, v138
    v_fma_f32 v139, v139, v135, v139
    v_rcp_f32 v136, v136
    v_rcp_f32 v137, v137
    v_rcp_f32 v138, v138
    v_rcp_f32 v139, v139
    v_sub_f32 v128, 1.0, v128
    v_sub_f32 v129, 1.0, v129
    v_sub_f32 v130, 1.0, v130
    v_sub_f32 v131, 1.0, v131
    v_mul_f32 v140, v128, v136
    v_mul_f32 v141, v129, v137
    v_mul_f32 v142, v130, v138
    v_mul_f32 v143, v131, v139
    v_cvt_pk_bf16_f32 v146, v140, v141
    v_cvt_pk_bf16_f32 v147, v142, v143
    ds_write_b128 v224, v[144:147] offset:7168
    s_mov_b64 exec, 1
    ds_add_u32 v239, v237 offset:92
    s_mov_b64 exec, -1
    s_add_u32 s34, s34, 1
    s_cmp_eq_u32 s34, 8
    s_cbranch_scc1 L_gdone
L_gl6:
    ds_read_b128 v[252:255], v224 offset:5120
    s_waitcnt lgkmcnt(1)
    s_cbranch_vccnz L_ro18
    v_mul_f32 v128, s42, v96
    v_mul_f32 v129, s42, v97
    v_mul_f32 v130, s42, v98
    v_mul_f32 v131, s42, v99
    v_fma_mix_f32 v132, s43, v248, 0 op_sel:[0,0,0] op_sel_hi:[0,1,0]
    v_fma_mix_f32 v133, s43, v248, 0 op_sel:[0,1,0] op_sel_hi:[0,1,0]
    v_fma_mix_f32 v134, s43, v249, 0 op_sel:[0,0,0] op_sel_hi:[0,1,0]
    v_fma_mix_f32 v135, s43, v249, 0 op_sel:[0,1,0] op_sel_hi:[0,1,0]
    s_branch L_re18
L_ro18:
    v_fma_mix_f32 v128, s42, v248, 0 op_sel:[0,0,0] op_sel_hi:[0,1,0]
    v_fma_mix_f32 v129, s42, v248, 0 op_sel:[0,1,0] op_sel_hi:[0,1,0]
    v_fma_mix_f32 v130, s42, v249, 0 op_sel:[0,0,0] op_sel_hi:[0,1,0]
    v_fma_mix_f32 v131, s42, v249, 0 op_sel:[0,1,0] op_sel_hi:[0,1,0]
    v_mul_f32 v132, s43, v104
    v_mul_f32 v133, s43, v105
    v_mul_f32 v134, s43, v106
    v_mul_f32 v135, s43, v107
L_re18:
    v_min_f32 v128, s44, v128
    v_min_f32 v129, s44, v129
    v_min_f32 v130, s44, v130
    v_min_f32 v131, s44, v131
    v_exp_f32 v132, v132
    v_exp_f32 v133, v133
    v_exp_f32 v134, v134
    v_exp_f32 v135, v135
    v_exp_f32 v128, v128
    v_exp_f32 v129, v129
    v_exp_f32 v130, v130
    v_exp_f32 v131, v131
    s_nop 0
    v_add_f32 v136, 1.0, v128
    v_add_f32 v137, 1.0, v129
    v_add_f32 v138, 1.0, v130
    v_add_f32 v139, 1.0, v131
    v_fma_f32 v136, v136, v132, v136
    v_fma_f32 v137, v137, v133, v137
    v_fma_f32 v138, v138, v134, v138
    v_fma_f32 v139, v139, v135, v139
    v_rcp_f32 v136, v136
    v_rcp_f32 v137, v137
    v_rcp_f32 v138, v138
    v_rcp_f32 v139, v139
    v_sub_f32 v128, 1.0, v128
    v_sub_f32 v129, 1.0, v129
    v_sub_f32 v130, 1.0, v130
    v_sub_f32 v131, 1.0, v131
    v_mul_f32 v140, v128, v136
    v_mul_f32 v141, v129, v137
    v_mul_f32 v142, v130, v138
    v_mul_f32 v143, v131, v139
    v_cvt_pk_bf16_f32 v148, v140, v141
    v_cvt_pk_bf16_f32 v149, v142, v143
    s_cbranch_vccnz L_ro19
    v_mul_f32 v128, s42, v100
    v_mul_f32 v129, s42, v101
    v_mul_f32 v130, s42, v102
    v_mul_f32 v131, s42, v103
    v_fma_mix_f32 v132, s43, v250, 0 op_sel:[0,0,0] op_sel_hi:[0,1,0]
    v_fma_mix_f32 v133, s43, v250, 0 op_sel:[0,1,0] op_sel_hi:[0,1,0]
    v_fma_mix_f32 v134, s43, v251, 0 op_sel:[0,0,0] op_sel_hi:[0,1,0]
    v_fma_mix_f32 v135, s43, v251, 0 op_sel:[0,1,0] op_sel_hi:[0,1,0]
    s_branch L_re19
L_ro19:
    v_fma_mix_f32 v128, s42, v250, 0 op_sel:[0,0,0] op_sel_hi:[0,1,0]
    v_fma_mix_f32 v129, s42, v250, 0 op_sel:[0,1,0] op_sel_hi:[0,1,0]
    v_fma_mix_f32 v130, s42, v251, 0 op_sel:[0,0,0] op_sel_hi:[0,1,0]
    v_fma_mix_f32 v131, s42, v251, 0 op_sel:[0,1,0] op_sel_hi:[0,1,0]
    v_mul_f32 v132, s43, v108
    v_mul_f32 v133, s43, v109
    v_mul_f32 v134, s43, v110
    v_mul_f32 v135, s43, v111
L_re19:
    v_min_f32 v128, s44, v128
    v_min_f32 v129, s44, v129
    v_min_f32 v130, s44, v130
    v_min_f32 v131, s44, v131
    v_exp_f32 v132, v132
    v_exp_f32 v133, v133
    v_exp_f32 v134, v134
    v_exp_f32 v135, v135
    v_exp_f32 v128, v128
    v_exp_f32 v129, v129
    v_exp_f32 v130, v130
    v_exp_f32 v131, v131
    s_nop 0
    v_add_f32 v136, 1.0, v128
    v_add_f32 v137, 1.0, v129
    v_add_f32 v138, 1.0, v130
    v_add_f32 v139, 1.0, v131
    v_fma_f32 v136, v136, v132, v136
    v_fma_f32 v137, v137, v133, v137
    v_fma_f32 v138, v138, v134, v138
    v_fma_f32 v139, v139, v135, v139
    v_rcp_f32 v136, v136
    v_rcp_f32 v137, v137
    v_rcp_f32 v138, v138
    v_rcp_f32 v139, v139
    v_sub_f32 v128, 1.0, v128
    v_sub_f32 v129, 1.0, v129
    v_sub_f32 v130, 1.0, v130
    v_sub_f32 v131, 1.0, v131
    v_mul_f32 v140, v128, v136
    v_mul_f32 v141, v129, v137
    v_mul_f32 v142, v130, v138
    v_mul_f32 v143, v131, v139
    v_cvt_pk_bf16_f32 v150, v140, v141
    v_cvt_pk_bf16_f32 v151, v142, v143
    ds_write_b128 v224, v[148:151] offset:6144
    s_mov_b64 exec, 1
    ds_add_u32 v239, v237 offset:88
    s_mov_b64 exec, -1
    s_add_u32 s34, s34, 1
    s_cmp_eq_u32 s34, 8
    s_cbranch_scc1 L_gdone
L_gl5:
    ds_read_b128 v[248:251], v224 offset:4096
    s_waitcnt lgkmcnt(1)
    s_cbranch_vccnz L_ro20
    v_mul_f32 v128, s42, v80
    v_mul_f32 v129, s42, v81
    v_mul_f32 v130, s42, v82
    v_mul_f32 v131, s42, v83
    v_fma_mix_f32 v132, s43, v252, 0 op_sel:[0,0,0] op_sel_hi:[0,1,0]
    v_fma_mix_f32 v133, s43, v252, 0 op_sel:[0,1,0] op_sel_hi:[0,1,0]
    v_fma_mix_f32 v134, s43, v253, 0 op_sel:[0,0,0] op_sel_hi:[0,1,0]
    v_fma_mix_f32 v135, s43, v253, 0 op_sel:[0,1,0] op_sel_hi:[0,1,0]
    s_branch L_re20
L_ro20:
    v_fma_mix_f32 v128, s42, v252, 0 op_sel:[0,0,0] op_sel_hi:[0,1,0]
    v_fma_mix_f32 v129, s42, v252, 0 op_sel:[0,1,0] op_sel_hi:[0,1,0]
    v_fma_mix_f32 v130, s42, v253, 0 op_sel:[0,0,0] op_sel_hi:[0,1,0]
    v_fma_mix_f32 v131, s42, v253, 0 op_sel:[0,1,0] op_sel_hi:[0,1,0]
    v_mul_f32 v132, s43, v88
    v_mul_f32 v133, s43, v89
    v_mul_f32 v134, s43, v90
    v_mul_f32 v135, s43, v91
L_re20:
    v_min_f32 v128, s44, v128
    v_min_f32 v129, s44, v129
    v_min_f32 v130, s44, v130
    v_min_f32 v131, s44, v131
    v_exp_f32 v132, v132
    v_exp_f32 v133, v133
    v_exp_f32 v134, v134
    v_exp_f32 v135, v135
    v_exp_f32 v128, v128
    v_exp_f32 v129, v129
    v_exp_f32 v130, v130
    v_exp_f32 v131, v131
    s_nop 0
    v_add_f32 v136, 1.0, v128
    v_add_f32 v137, 1.0, v129
    v_add_f32 v138, 1.0, v130
    v_add_f32 v139, 1.0, v131
    v_fma_f32 v136, v136, v132, v136
    v_fma_f32 v137, v137, v133, v137
    v_fma_f32 v138, v138, v134, v138
    v_fma_f32 v139, v139, v135, v139
    v_rcp_f32 v136, v136
    v_rcp_f32 v137, v137
    v_rcp_f32 v138, v138
    v_rcp_f32 v139, v139
    v_sub_f32 v128, 1.0, v128
    v_sub_f32 v129, 1.0, v129
    v_sub_f32 v130, 1.0, v130
    v_sub_f32 v131, 1.0, v131
    v_mul_f32 v140, v128, v136
    v_mul_f32 v141, v129, v137
    v_mul_f32 v142, v130, v138
    v_mul_f32 v143, v131, v139
    v_cvt_pk_bf16_f32 v152, v140, v141
    v_cvt_pk_bf16_f32 v153, v142, v143
    s_cbranch_vccnz L_ro21
    v_mul_f32 v128, s42, v84
    v_mul_f32 v129, s42, v85
    v_mul_f32 v130, s42, v86
    v_mul_f32 v131, s42, v87
    v_fma_mix_f32 v132, s43, v254, 0 op_sel:[0,0,0] op_sel_hi:[0,1,0]
    v_fma_mix_f32 v133, s43, v254, 0 op_sel:[0,1,0] op_sel_hi:[0,1,0]
    v_fma_mix_f32 v134, s43, v255, 0 op_sel:[0,0,0] op_sel_hi:[0,1,0]
    v_fma_mix_f32 v135, s43, v255, 0 op_sel:[0,1,0] op_sel_hi:[0,1,0]
    s_branch L_re21
L_ro21:
    v_fma_mix_f32 v128, s42, v254, 0 op_sel:[0,0,0] op_sel_hi:[0,1,0]
    v_fma_mix_f32 v129, s42, v254, 0 op_sel:[0,1,0] op_sel_hi:[0,1,0]
    v_fma_mix_f32 v130, s42, v255, 0 op_sel:[0,0,0] op_sel_hi:[0,1,0]
    v_fma_mix_f32 v131, s42, v255, 0 op_sel:[0,1,0] op_sel_hi:[0,1,0]
    v_mul_f32 v132, s43, v92
    v_mul_f32 v133, s43, v93
    v_mul_f32 v134, s43, v94
    v_mul_f32 v135, s43, v95
L_re21:
    v_min_f32 v128, s44, v128
    v_min_f32 v129, s44, v129
    v_min_f32 v130, s44, v130
    v_min_f32 v131, s44, v131
    v_exp_f32 v132, v132
    v_exp_f32 v133, v133
    v_exp_f32 v134, v134
    v_exp_f32 v135, v135
    v_exp_f32 v128, v128
    v_exp_f32 v129, v129
    v_exp_f32 v130, v130
    v_exp_f32 v131, v131
    s_nop 0
    v_add_f32 v136, 1.0, v128
    v_add_f32 v137, 1.0, v129
    v_add_f32 v138, 1.0, v130
    v_add_f32 v139, 1.0, v131
    v_fma_f32 v136, v136, v132, v136
    v_fma_f32 v137, v137, v133, v137
    v_fma_f32 v138, v138, v134, v138
    v_fma_f32 v139, v139, v135, v139
    v_rcp_f32 v136, v136
    v_rcp_f32 v137, v137
    v_rcp_f32 v138, v138
    v_rcp_f32 v139, v139
    v_sub_f32 v128, 1.0, v128
    v_sub_f32 v129, 1.0, v129
    v_sub_f32 v130, 1.0, v130
    v_sub_f32 v131, 1.0, v131
    v_mul_f32 v140, v128, v136
    v_mul_f32 v141, v129, v137
    v_mul_f32 v142, v130, v138
    v_mul_f32 v143, v131, v139
    v_cvt_pk_bf16_f32 v154, v140, v141
    v_cvt_pk_bf16_f32 v155, v142, v143
    ds_write_b128 v224, v[152:155] offset:5120
    s_mov_b64 exec, 1
    ds_add_u32 v239, v237 offset:84
    s_mov_b64 exec, -1
    s_add_u32 s34, s34, 1
    s_cmp_eq_u32 s34, 8
    s_cbranch_scc1 L_gdone
L_gl4:
    ds_read_b128 v[252:255], v224 offset:3072
    s_waitcnt lgkmcnt(1)
    s_cbranch_vccnz L_ro22
    v_mul_f32 v128, s42, v64
    v_mul_f32 v129, s42, v65
    v_mul_f32 v130, s42, v66
    v_mul_f32 v131, s42, v67
    v_fma_mix_f32 v132, s43, v248, 0 op_sel:[0,0,0] op_sel_hi:[0,1,0]
    v_fma_mix_f32 v133, s43, v248, 0 op_sel:[0,1,0] op_sel_hi:[0,1,0]
    v_fma_mix_f32 v134, s43, v249, 0 op_sel:[0,0,0] op_sel_hi:[0,1,0]
    v_fma_mix_f32 v135, s43, v249, 0 op_sel:[0,1,0] op_sel_hi:[0,1,0]
    s_branch L_re22
L_ro22:
    v_fma_mix_f32 v128, s42, v248, 0 op_sel:[0,0,0] op_sel_hi:[0,1,0]
    v_fma_mix_f32 v129, s42, v248, 0 op_sel:[0,1,0] op_sel_hi:[0,1,0]
    v_fma_mix_f32 v130, s42, v249, 0 op_sel:[0,0,0] op_sel_hi:[0,1,0]
    v_fma_mix_f32 v131, s42, v249, 0 op_sel:[0,1,0] op_sel_hi:[0,1,0]
    v_mul_f32 v132, s43, v72
    v_mul_f32 v133, s43, v73
    v_mul_f32 v134, s43, v74
    v_mul_f32 v135, s43, v75
L_re22:
    v_min_f32 v128, s44, v128
    v_min_f32 v129, s44, v129
    v_min_f32 v130, s44, v130
    v_min_f32 v131, s44, v131
    v_exp_f32 v132, v132
    v_exp_f32 v133, v133
    v_exp_f32 v134, v134
    v_exp_f32 v135, v135
    v_exp_f32 v128, v128
    v_exp_f32 v129, v129
    v_exp_f32 v130, v130
    v_exp_f32 v131, v131
    s_nop 0
    v_add_f32 v136, 1.0, v128
    v_add_f32 v137, 1.0, v129
    v_add_f32 v138, 1.0, v130
    v_add_f32 v139, 1.0, v131
    v_fma_f32 v136, v136, v132, v136
    v_fma_f32 v137, v137, v133, v137
    v_fma_f32 v138, v138, v134, v138
    v_fma_f32 v139, v139, v135, v139
    v_rcp_f32 v136, v136
    v_rcp_f32 v137, v137
    v_rcp_f32 v138, v138
    v_rcp_f32 v139, v139
    v_sub_f32 v128, 1.0, v128
    v_sub_f32 v129, 1.0, v129
    v_sub_f32 v130, 1.0, v130
    v_sub_f32 v131, 1.0, v131
    v_mul_f32 v140, v128, v136
    v_mul_f32 v141, v129, v137
    v_mul_f32 v142, v130, v138
    v_mul_f32 v143, v131, v139
    v_cvt_pk_bf16_f32 v156, v140, v141
    v_cvt_pk_bf16_f32 v157, v142, v143
    s_cbranch_vccnz L_ro23
    v_mul_f32 v128, s42, v68
    v_mul_f32 v129, s42, v69
    v_mul_f32 v130, s42, v70
    v_mul_f32 v131, s42, v71
    v_fma_mix_f32 v132, s43, v250, 0 op_sel:[0,0,0] op_sel_hi:[0,1,0]
    v_fma_mix_f32 v133, s43, v250, 0 op_sel:[0,1,0] op_sel_hi:[0,1,0]
    v_fma_mix_f32 v134, s43, v251, 0 op_sel:[0,0,0] op_sel_hi:[0,1,0]
    v_fma_mix_f32 v135, s43, v251, 0 op_sel:[0,1,0] op_sel_hi:[0,1,0]
    s_branch L_re23
L_ro23:
    v_fma_mix_f32 v128, s42, v250, 0 op_sel:[0,0,0] op_sel_hi:[0,1,0]
    v_fma_mix_f32 v129, s42, v250, 0 op_sel:[0,1,0] op_sel_hi:[0,1,0]
    v_fma_mix_f32 v130, s42, v251, 0 op_sel:[0,0,0] op_sel_hi:[0,1,0]
    v_fma_mix_f32 v131, s42, v251, 0 op_sel:[0,1,0] op_sel_hi:[0,1,0]
    v_mul_f32 v132, s43, v76
    v_mul_f32 v133, s43, v77
    v_mul_f32 v134, s43, v78
    v_mul_f32 v135, s43, v79
L_re23:
    v_min_f32 v128, s44, v128
    v_min_f32 v129, s44, v129
    v_min_f32 v130, s44, v130
    v_min_f32 v131, s44, v131
    v_exp_f32 v132, v132
    v_exp_f32 v133, v133
    v_exp_f32 v134, v134
    v_exp_f32 v135, v135
    v_exp_f32 v128, v128
    v_exp_f32 v129, v129
    v_exp_f32 v130, v130
    v_exp_f32 v131, v131
    s_nop 0
    v_add_f32 v136, 1.0, v128
    v_add_f32 v137, 1.0, v129
    v_add_f32 v138, 1.0, v130
    v_add_f32 v139, 1.0, v131
    v_fma_f32 v136, v136, v132, v136
    v_fma_f32 v137, v137, v133, v137
    v_fma_f32 v138, v138, v134, v138
    v_fma_f32 v139, v139, v135, v139
    v_rcp_f32 v136, v136
    v_rcp_f32 v137, v137
    v_rcp_f32 v138, v138
    v_rcp_f32 v139, v139
    v_sub_f32 v128, 1.0, v128
    v_sub_f32 v129, 1.0, v129
    v_sub_f32 v130, 1.0, v130
    v_sub_f32 v131, 1.0, v131
    v_mul_f32 v140, v128, v136
    v_mul_f32 v141, v129, v137
    v_mul_f32 v142, v130, v138
    v_mul_f32 v143, v131, v139
    v_cvt_pk_bf16_f32 v158, v140, v141
    v_cvt_pk_bf16_f32 v159, v142, v143
    ds_write_b128 v224, v[156:159] offset:4096
    s_mov_b64 exec, 1
    ds_add_u32 v239, v237 offset:80
    s_mov_b64 exec, -1
    s_add_u32 s34, s34, 1
    s_cmp_eq_u32 s34, 8
    s_cbranch_scc1 L_gdone
L_gl3:
    ds_read_b128 v[248:251], v224 offset:2048
    s_waitcnt lgkmcnt(1)
    s_cbranch_vccnz L_ro24
    v_mul_f32 v128, s42, v48
    v_mul_f32 v129, s42, v49
    v_mul_f32 v130, s42, v50
    v_mul_f32 v131, s42, v51
    v_fma_mix_f32 v132, s43, v252, 0 op_sel:[0,0,0] op_sel_hi:[0,1,0]
    v_fma_mix_f32 v133, s43, v252, 0 op_sel:[0,1,0] op_sel_hi:[0,1,0]
    v_fma_mix_f32 v134, s43, v253, 0 op_sel:[0,0,0] op_sel_hi:[0,1,0]
    v_fma_mix_f32 v135, s43, v253, 0 op_sel:[0,1,0] op_sel_hi:[0,1,0]
    s_branch L_re24
L_ro24:
    v_fma_mix_f32 v128, s42, v252, 0 op_sel:[0,0,0] op_sel_hi:[0,1,0]
    v_fma_mix_f32 v129, s42, v252, 0 op_sel:[0,1,0] op_sel_hi:[0,1,0]
    v_fma_mix_f32 v130, s42, v253, 0 op_sel:[0,0,0] op_sel_hi:[0,1,0]
    v_fma_mix_f32 v131, s42, v253, 0 op_sel:[0,1,0] op_sel_hi:[0,1,0]
    v_mul_f32 v132, s43, v56
    v_mul_f32 v133, s43, v57
    v_mul_f32 v134, s43, v58
    v_mul_f32 v135, s43, v59
L_re24:
    v_min_f32 v128, s44, v128
    v_min_f32 v129, s44, v129
    v_min_f32 v130, s44, v130
    v_min_f32 v131, s44, v131
    v_exp_f32 v132, v132
    v_exp_f32 v133, v133
    v_exp_f32 v134, v134
    v_exp_f32 v135, v135
    v_exp_f32 v128, v128
    v_exp_f32 v129, v129
    v_exp_f32 v130, v130
    v_exp_f32 v131, v131
    s_nop 0
    v_add_f32 v136, 1.0, v128
    v_add_f32 v137, 1.0, v129
    v_add_f32 v138, 1.0, v130
    v_add_f32 v139, 1.0, v131
    v_fma_f32 v136, v136, v132, v136
    v_fma_f32 v137, v137, v133, v137
    v_fma_f32 v138, v138, v134, v138
    v_fma_f32 v139, v139, v135, v139
    v_rcp_f32 v136, v136
    v_rcp_f32 v137, v137
    v_rcp_f32 v138, v138
    v_rcp_f32 v139, v139
    v_sub_f32 v128, 1.0, v128
    v_sub_f32 v129, 1.0, v129
    v_sub_f32 v130, 1.0, v130
    v_sub_f32 v131, 1.0, v131
    v_mul_f32 v140, v128, v136
    v_mul_f32 v141, v129, v137
    v_mul_f32 v142, v130, v138
    v_mul_f32 v143, v131, v139
    v_cvt_pk_bf16_f32 v144, v140, v141
    v_cvt_pk_bf16_f32 v145, v142, v143
    s_cbranch_vccnz L_ro25
    v_mul_f32 v128, s42, v52
    v_mul_f32 v129, s42, v53
    v_mul_f32 v130, s42, v54
    v_mul_f32 v131, s42, v55
    v_fma_mix_f32 v132, s43, v254, 0 op_sel:[0,0,0] op_sel_hi:[0,1,0]
    v_fma_mix_f32 v133, s43, v254, 0 op_sel:[0,1,0] op_sel_hi:[0,1,0]
    v_fma_mix_f32 v134, s43, v255, 0 op_sel:[0,0,0] op_sel_hi:[0,1,0]
    v_fma_mix_f32 v135, s43, v255, 0 op_sel:[0,1,0] op_sel_hi:[0,1,0]
    s_branch L_re25
L_ro25:
    v_fma_mix_f32 v128, s42, v254, 0 op_sel:[0,0,0] op_sel_hi:[0,1,0]
    v_fma_mix_f32 v129, s42, v254, 0 op_sel:[0,1,0] op_sel_hi:[0,1,0]
    v_fma_mix_f32 v130, s42, v255, 0 op_sel:[0,0,0] op_sel_hi:[0,1,0]
    v_fma_mix_f32 v131, s42, v255, 0 op_sel:[0,1,0] op_sel_hi:[0,1,0]
    v_mul_f32 v132, s43, v60
    v_mul_f32 v133, s43, v61
    v_mul_f32 v134, s43, v62
    v_mul_f32 v135, s43, v63
L_re25:
    v_min_f32 v128, s44, v128
    v_min_f32 v129, s44, v129
    v_min_f32 v130, s44, v130
    v_min_f32 v131, s44, v131
    v_exp_f32 v132, v132
    v_exp_f32 v133, v133
    v_exp_f32 v134, v134
    v_exp_f32 v135, v135
    v_exp_f32 v128, v128
    v_exp_f32 v129, v129
    v_exp_f32 v130, v130
    v_exp_f32 v131, v131
    s_nop 0
    v_add_f32 v136, 1.0, v128
    v_add_f32 v137, 1.0, v129
    v_add_f32 v138, 1.0, v130
    v_add_f32 v139, 1.0, v131
    v_fma_f32 v136, v136, v132, v136
    v_fma_f32 v137, v137, v133, v137
    v_fma_f32 v138, v138, v134, v138
    v_fma_f32 v139, v139, v135, v139
    v_rcp_f32 v136, v136
    v_rcp_f32 v137, v137
    v_rcp_f32 v138, v138
    v_rcp_f32 v139, v139
    v_sub_f32 v128, 1.0, v128
    v_sub_f32 v129, 1.0, v129
    v_sub_f32 v130, 1.0, v130
    v_sub_f32 v131, 1.0, v131
    v_mul_f32 v140, v128, v136
    v_mul_f32 v141, v129, v137
    v_mul_f32 v142, v130, v138
    v_mul_f32 v143, v131, v139
    v_cvt_pk_bf16_f32 v146, v140, v141
    v_cvt_pk_bf16_f32 v147, v142, v143
    ds_write_b128 v224, v[144:147] offset:3072
    s_mov_b64 exec, 1
    ds_add_u32 v239, v237 offset:76
    s_mov_b64 exec, -1
    s_add_u32 s34, s34, 1
    s_cmp_eq_u32 s34, 8
    s_cbranch_scc1 L_gdone
L_gl2:
    ds_read_b128 v[252:255], v224 offset:1024
    s_waitcnt lgkmcnt(1)
    s_cbranch_vccnz L_ro26
    v_mul_f32 v128, s42, v32
    v_mul_f32 v129, s42, v33
    v_mul_f32 v130, s42, v34
    v_mul_f32 v131, s42, v35
    v_fma_mix_f32 v132, s43, v248, 0 op_sel:[0,0,0] op_sel_hi:[0,1,0]
    v_fma_mix_f32 v133, s43, v248, 0 op_sel:[0,1,0] op_sel_hi:[0,1,0]
    v_fma_mix_f32 v134, s43, v249, 0 op_sel:[0,0,0] op_sel_hi:[0,1,0]
    v_fma_mix_f32 v135, s43, v249, 0 op_sel:[0,1,0] op_sel_hi:[0,1,0]
    s_branch L_re26
L_ro26:
    v_fma_mix_f32 v128, s42, v248, 0 op_sel:[0,0,0] op_sel_hi:[0,1,0]
    v_fma_mix_f32 v129, s42, v248, 0 op_sel:[0,1,0] op_sel_hi:[0,1,0]
    v_fma_mix_f32 v130, s42, v249, 0 op_sel:[0,0,0] op_sel_hi:[0,1,0]
    v_fma_mix_f32 v131, s42, v249, 0 op_sel:[0,1,0] op_sel_hi:[0,1,0]
    v_mul_f32 v132, s43, v40
    v_mul_f32 v133, s43, v41
    v_mul_f32 v134, s43, v42
    v_mul_f32 v135, s43, v43
L_re26:
    v_min_f32 v128, s44, v128
    v_min_f32 v129, s44, v129
    v_min_f32 v130, s44, v130
    v_min_f32 v131, s44, v131
    v_exp_f32 v132, v132
    v_exp_f32 v133, v133
    v_exp_f32 v134, v134
    v_exp_f32 v135, v135
    v_exp_f32 v128, v128
    v_exp_f32 v129, v129
    v_exp_f32 v130, v130
    v_exp_f32 v131, v131
    s_nop 0
    v_add_f32 v136, 1.0, v128
    v_add_f32 v137, 1.0, v129
    v_add_f32 v138, 1.0, v130
    v_add_f32 v139, 1.0, v131
    v_fma_f32 v136, v136, v132, v136
    v_fma_f32 v137, v137, v133, v137
    v_fma_f32 v138, v138, v134, v138
    v_fma_f32 v139, v139, v135, v139
    v_rcp_f32 v136, v136
    v_rcp_f32 v137, v137
    v_rcp_f32 v138, v138
    v_rcp_f32 v139, v139
    v_sub_f32 v128, 1.0, v128
    v_sub_f32 v129, 1.0, v129
    v_sub_f32 v130, 1.0, v130
    v_sub_f32 v131, 1.0, v131
    v_mul_f32 v140, v128, v136
    v_mul_f32 v141, v129, v137
    v_mul_f32 v142, v130, v138
    v_mul_f32 v143, v131, v139
    v_cvt_pk_bf16_f32 v148, v140, v141
    v_cvt_pk_bf16_f32 v149, v142, v143
    s_cbranch_vccnz L_ro27
    v_mul_f32 v128, s42, v36
    v_mul_f32 v129, s42, v37
    v_mul_f32 v130, s42, v38
    v_mul_f32 v131, s42, v39
    v_fma_mix_f32 v132, s43, v250, 0 op_sel:[0,0,0] op_sel_hi:[0,1,0]
    v_fma_mix_f32 v133, s43, v250, 0 op_sel:[0,1,0] op_sel_hi:[0,1,0]
    v_fma_mix_f32 v134, s43, v251, 0 op_sel:[0,0,0] op_sel_hi:[0,1,0]
    v_fma_mix_f32 v135, s43, v251, 0 op_sel:[0,1,0] op_sel_hi:[0,1,0]
    s_branch L_re27
L_ro27:
    v_fma_mix_f32 v128, s42, v250, 0 op_sel:[0,0,0] op_sel_hi:[0,1,0]
    v_fma_mix_f32 v129, s42, v250, 0 op_sel:[0,1,0] op_sel_hi:[0,1,0]
    v_fma_mix_f32 v130, s42, v251, 0 op_sel:[0,0,0] op_sel_hi:[0,1,0]
    v_fma_mix_f32 v131, s42, v251, 0 op_sel:[0,1,0] op_sel_hi:[0,1,0]
    v_mul_f32 v132, s43, v44
    v_mul_f32 v133, s43, v45
    v_mul_f32 v134, s43, v46
    v_mul_f32 v135, s43, v47
L_re27:
    v_min_f32 v128, s44, v128
    v_min_f32 v129, s44, v129
    v_min_f32 v130, s44, v130
    v_min_f32 v131, s44, v131
    v_exp_f32 v132, v132
    v_exp_f32 v133, v133
    v_exp_f32 v134, v134
    v_exp_f32 v135, v135
    v_exp_f32 v128, v128
    v_exp_f32 v129, v129
    v_exp_f32 v130, v130
    v_exp_f32 v131, v131
    s_nop 0
    v_add_f32 v136, 1.0, v128
    v_add_f32 v137, 1.0, v129
    v_add_f32 v138, 1.0, v130
    v_add_f32 v139, 1.0, v131
    v_fma_f32 v136, v136, v132, v136
    v_fma_f32 v137, v137, v133, v137
    v_fma_f32 v138, v138, v134, v138
    v_fma_f32 v139, v139, v135, v139
    v_rcp_f32 v136, v136
    v_rcp_f32 v137, v137
    v_rcp_f32 v138, v138
    v_rcp_f32 v139, v139
    v_sub_f32 v128, 1.0, v128
    v_sub_f32 v129, 1.0, v129
    v_sub_f32 v130, 1.0, v130
    v_sub_f32 v131, 1.0, v131
    v_mul_f32 v140, v128, v136
    v_mul_f32 v141, v129, v137
    v_mul_f32 v142, v130, v138
    v_mul_f32 v143, v131, v139
    v_cvt_pk_bf16_f32 v150, v140, v141
    v_cvt_pk_bf16_f32 v151, v142, v143
    ds_write_b128 v224, v[148:151] offset:2048
    s_mov_b64 exec, 1
    ds_add_u32 v239, v237 offset:72
    s_mov_b64 exec, -1
    s_add_u32 s34, s34, 1
    s_cmp_eq_u32 s34, 8
    s_cbranch_scc1 L_gdone
L_gl1:
    ds_read_b128 v[248:251], v224 offset:0
    s_waitcnt lgkmcnt(1)
    s_cbranch_vccnz L_ro28
    v_mul_f32 v128, s42, v16
    v_mul_f32 v129, s42, v17
    v_mul_f32 v130, s42, v18
    v_mul_f32 v131, s42, v19
    v_fma_mix_f32 v132, s43, v252, 0 op_sel:[0,0,0] op_sel_hi:[0,1,0]
    v_fma_mix_f32 v133, s43, v252, 0 op_sel:[0,1,0] op_sel_hi:[0,1,0]
    v_fma_mix_f32 v134, s43, v253, 0 op_sel:[0,0,0] op_sel_hi:[0,1,0]
    v_fma_mix_f32 v135, s43, v253, 0 op_sel:[0,1,0] op_sel_hi:[0,1,0]
    s_branch L_re28
L_ro28:
    v_fma_mix_f32 v128, s42, v252, 0 op_sel:[0,0,0] op_sel_hi:[0,1,0]
    v_fma_mix_f32 v129, s42, v252, 0 op_sel:[0,1,0] op_sel_hi:[0,1,0]
    v_fma_mix_f32 v130, s42, v253, 0 op_sel:[0,0,0] op_sel_hi:[0,1,0]
    v_fma_mix_f32 v131, s42, v253, 0 op_sel:[0,1,0] op_sel_hi:[0,1,0]
    v_mul_f32 v132, s43, v24
    v_mul_f32 v133, s43, v25
    v_mul_f32 v134, s43, v26
    v_mul_f32 v135, s43, v27
L_re28:
    v_min_f32 v128, s44, v128
    v_min_f32 v129, s44, v129
    v_min_f32 v130, s44, v130
    v_min_f32 v131, s44, v131
    v_exp_f32 v132, v132
    v_exp_f32 v133, v133
    v_exp_f32 v134, v134
    v_exp_f32 v135, v135
    v_exp_f32 v128, v128
    v_exp_f32 v129, v129
    v_exp_f32 v130, v130
    v_exp_f32 v131, v131
    s_nop 0
    v_add_f32 v136, 1.0, v128
    v_add_f32 v137, 1.0, v129
    v_add_f32 v138, 1.0, v130
    v_add_f32 v139, 1.0, v131
    v_fma_f32 v136, v136, v132, v136
    v_fma_f32 v137, v137, v133, v137
    v_fma_f32 v138, v138, v134, v138
    v_fma_f32 v139, v139, v135, v139
    v_rcp_f32 v136, v136
    v_rcp_f32 v137, v137
    v_rcp_f32 v138, v138
    v_rcp_f32 v139, v139
    v_sub_f32 v128, 1.0, v128
    v_sub_f32 v129, 1.0, v129
    v_sub_f32 v130, 1.0, v130
    v_sub_f32 v131, 1.0, v131
    v_mul_f32 v140, v128, v136
    v_mul_f32 v141, v129, v137
    v_mul_f32 v142, v130, v138
    v_mul_f32 v143, v131, v139
    v_cvt_pk_bf16_f32 v152, v140, v141
    v_cvt_pk_bf16_f32 v153, v142, v143
    s_cbranch_vccnz L_ro29
    v_mul_f32 v128, s42, v20
    v_mul_f32 v129, s42, v21
    v_mul_f32 v130, s42, v22
    v_mul_f32 v131, s42, v23
    v_fma_mix_f32 v132, s43, v254, 0 op_sel:[0,0,0] op_sel_hi:[0,1,0]
    v_fma_mix_f32 v133, s43, v254, 0 op_sel:[0,1,0] op_sel_hi:[0,1,0]
    v_fma_mix_f32 v134, s43, v255, 0 op_sel:[0,0,0] op_sel_hi:[0,1,0]
    v_fma_mix_f32 v135, s43, v255, 0 op_sel:[0,1,0] op_sel_hi:[0,1,0]
    s_branch L_re29
L_ro29:
    v_fma_mix_f32 v128, s42, v254, 0 op_sel:[0,0,0] op_sel_hi:[0,1,0]
    v_fma_mix_f32 v129, s42, v254, 0 op_sel:[0,1,0] op_sel_hi:[0,1,0]
    v_fma_mix_f32 v130, s42, v255, 0 op_sel:[0,0,0] op_sel_hi:[0,1,0]
    v_fma_mix_f32 v131, s42, v255, 0 op_sel:[0,1,0] op_sel_hi:[0,1,0]
    v_mul_f32 v132, s43, v28
    v_mul_f32 v133, s43, v29
    v_mul_f32 v134, s43, v30
    v_mul_f32 v135, s43, v31
L_re29:
    v_min_f32 v128, s44, v128
    v_min_f32 v129, s44, v129
    v_min_f32 v130, s44, v130
    v_min_f32 v131, s44, v131
    v_exp_f32 v132, v132
    v_exp_f32 v133, v133
    v_exp_f32 v134, v134
    v_exp_f32 v135, v135
    v_exp_f32 v128, v128
    v_exp_f32 v129, v129
    v_exp_f32 v130, v130
    v_exp_f32 v131, v131
    s_nop 0
    v_add_f32 v136, 1.0, v128
    v_add_f32 v137, 1.0, v129
    v_add_f32 v138, 1.0, v130
    v_add_f32 v139, 1.0, v131
    v_fma_f32 v136, v136, v132, v136
    v_fma_f32 v137, v137, v133, v137
    v_fma_f32 v138, v138, v134, v138
    v_fma_f32 v139, v139, v135, v139
    v_rcp_f32 v136, v136
    v_rcp_f32 v137, v137
    v_rcp_f32 v138, v138
    v_rcp_f32 v139, v139
    v_sub_f32 v128, 1.0, v128
    v_sub_f32 v129, 1.0, v129
    v_sub_f32 v130, 1.0, v130
    v_sub_f32 v131, 1.0, v131
    v_mul_f32 v140, v128, v136
    v_mul_f32 v141, v129, v137
    v_mul_f32 v142, v130, v138
    v_mul_f32 v143, v131, v139
    v_cvt_pk_bf16_f32 v154, v140, v141
    v_cvt_pk_bf16_f32 v155, v142, v143
    ds_write_b128 v224, v[152:155] offset:1024
    s_mov_b64 exec, 1
    ds_add_u32 v239, v237 offset:68
    s_mov_b64 exec, -1
    s_add_u32 s34, s34, 1
    s_cmp_eq_u32 s34, 8
    s_cbranch_scc1 L_gdone
L_gl0:
    ds_read_b128 v[252:255], v224 offset:7168
    s_waitcnt lgkmcnt(1)
    s_cbranch_vccnz L_ro30
    v_mul_f32 v128, s42, v0
    v_mul_f32 v129, s42, v1
    v_mul_f32 v130, s42, v2
    v_mul_f32 v131, s42, v3
    v_fma_mix_f32 v132, s43, v248, 0 op_sel:[0,0,0] op_sel_hi:[0,1,0]
    v_fma_mix_f32 v133, s43, v248, 0 op_sel:[0,1,0] op_sel_hi:[0,1,0]
    v_fma_mix_f32 v134, s43, v249, 0 op_sel:[0,0,0] op_sel_hi:[0,1,0]
    v_fma_mix_f32 v135, s43, v249, 0 op_sel:[0,1,0] op_sel_hi:[0,1,0]
    s_branch L_re30
L_ro30:
    v_fma_mix_f32 v128, s42, v248, 0 op_sel:[0,0,0] op_sel_hi:[0,1,0]
    v_fma_mix_f32 v129, s42, v248, 0 op_sel:[0,1,0] op_sel_hi:[0,1,0]
    v_fma_mix_f32 v130, s42, v249, 0 op_sel:[0,0,0] op_sel_hi:[0,1,0]
    v_fma_mix_f32 v131, s42, v249, 0 op_sel:[0,1,0] op_sel_hi:[0,1,0]
    v_mul_f32 v132, s43, v8
    v_mul_f32 v133, s43, v9
    v_mul_f32 v134, s43, v10
    v_mul_f32 v135, s43, v11
L_re30:
    v_min_f32 v128, s44, v128
    v_min_f32 v129, s44, v129
    v_min_f32 v130, s44, v130
    v_min_f32 v131, s44, v131
    v_exp_f32 v132, v132
    v_exp_f32 v133, v133
    v_exp_f32 v134, v134
    v_exp_f32 v135, v135
    v_exp_f32 v128, v128
    v_exp_f32 v129, v129
    v_exp_f32 v130, v130
    v_exp_f32 v131, v131
    s_nop 0
    v_add_f32 v136, 1.0, v128
    v_add_f32 v137, 1.0, v129
    v_add_f32 v138, 1.0, v130
    v_add_f32 v139, 1.0, v131
    v_fma_f32 v136, v136, v132, v136
    v_fma_f32 v137, v137, v133, v137
    v_fma_f32 v138, v138, v134, v138
    v_fma_f32 v139, v139, v135, v139
    v_rcp_f32 v136, v136
    v_rcp_f32 v137, v137
    v_rcp_f32 v138, v138
    v_rcp_f32 v139, v139
    v_sub_f32 v128, 1.0, v128
    v_sub_f32 v129, 1.0, v129
    v_sub_f32 v130, 1.0, v130
    v_sub_f32 v131, 1.0, v131
    v_mul_f32 v140, v128, v136
    v_mul_f32 v141, v129, v137
    v_mul_f32 v142, v130, v138
    v_mul_f32 v143, v131, v139
    v_cvt_pk_bf16_f32 v156, v140, v141
    v_cvt_pk_bf16_f32 v157, v142, v143
    s_cbranch_vccnz L_ro31
    v_mul_f32 v128, s42, v4
    v_mul_f32 v129, s42, v5
    v_mul_f32 v130, s42, v6
    v_mul_f32 v131, s42, v7
    v_fma_mix_f32 v132, s43, v250, 0 op_sel:[0,0,0] op_sel_hi:[0,1,0]
    v_fma_mix_f32 v133, s43, v250, 0 op_sel:[0,1,0] op_sel_hi:[0,1,0]
    v_fma_mix_f32 v134, s43, v251, 0 op_sel:[0,0,0] op_sel_hi:[0,1,0]
    v_fma_mix_f32 v135, s43, v251, 0 op_sel:[0,1,0] op_sel_hi:[0,1,0]
    s_branch L_re31
L_ro31:
    v_fma_mix_f32 v128, s42, v250, 0 op_sel:[0,0,0] op_sel_hi:[0,1,0]
    v_fma_mix_f32 v129, s42, v250, 0 op_sel:[0,1,0] op_sel_hi:[0,1,0]
    v_fma_mix_f32 v130, s42, v251, 0 op_sel:[0,0,0] op_sel_hi:[0,1,0]
    v_fma_mix_f32 v131, s42, v251, 0 op_sel:[0,1,0] op_sel_hi:[0,1,0]
    v_mul_f32 v132, s43, v12
    v_mul_f32 v133, s43, v13
    v_mul_f32 v134, s43, v14
    v_mul_f32 v135, s43, v15
L_re31:
    v_min_f32 v128, s44, v128
    v_min_f32 v129, s44, v129
    v_min_f32 v130, s44, v130
    v_min_f32 v131, s44, v131
    v_exp_f32 v132, v132
    v_exp_f32 v133, v133
    v_exp_f32 v134, v134
    v_exp_f32 v135, v135
    v_exp_f32 v128, v128
    v_exp_f32 v129, v129
    v_exp_f32 v130, v130
    v_exp_f32 v131, v131
    s_nop 0
    v_add_f32 v136, 1.0, v128
    v_add_f32 v137, 1.0, v129
    v_add_f32 v138, 1.0, v130
    v_add_f32 v139, 1.0, v131
    v_fma_f32 v136, v136, v132, v136
    v_fma_f32 v137, v137, v133, v137
    v_fma_f32 v138, v138, v134, v138
    v_fma_f32 v139, v139, v135, v139
    v_rcp_f32 v136, v136
    v_rcp_f32 v137, v137
    v_rcp_f32 v138, v138
    v_rcp_f32 v139, v139
    v_sub_f32 v128, 1.0, v128
    v_sub_f32 v129, 1.0, v129
    v_sub_f32 v130, 1.0, v130
    v_sub_f32 v131, 1.0, v131
    v_mul_f32 v140, v128, v136
    v_mul_f32 v141, v129, v137
    v_mul_f32 v142, v130, v138
    v_mul_f32 v143, v131, v139
    v_cvt_pk_bf16_f32 v158, v140, v141
    v_cvt_pk_bf16_f32 v159, v142, v143
    ds_write_b128 v224, v[156:159] offset:0
    s_mov_b64 exec, 1
    ds_add_u32 v239, v237 offset:64
    s_mov_b64 exec, -1
    s_add_u32 s34, s34, 1
    s_cmp_eq_u32 s34, 8
    s_cbranch_scc0 L_gl7
L_gdone:
    s_waitcnt lgkmcnt(0)
L_end:
    s_endpgm
.section .rodata,"a"
.p2align 6
.amdhsa_kernel standalone__autoregressive_conv_wavenet__speech_kernel
  .amdhsa_next_free_vgpr 256
  .amdhsa_next_free_sgpr 102
  .amdhsa_accum_offset 256
  .amdhsa_group_segment_fixed_size 0
  .amdhsa_kernarg_size 48
  .amdhsa_user_sgpr_count 2
  .amdhsa_user_sgpr_kernarg_segment_ptr 1
  .amdhsa_system_sgpr_workgroup_id_x 1
.end_amdhsa_kernel
```
